```python
import torch

def _softmax(x, axis=-1):
    return torch.softmax(x, dim=axis)
def _gelu(x):
    return torch.nn.functional.gelu(x, approximate="tanh")
def _silu(x):
    return torch.nn.functional.silu(x)
def _sigmoid(x):
    return torch.sigmoid(x)
def _layernorm(x, axis=-1, eps=1e-5):
    m = x.mean(dim=axis, keepdim=True)
    v = x.var(dim=axis, keepdim=True, unbiased=False)
    return (x - m) / torch.sqrt(v + eps)
def _scatter_add(tgt, idx, src, axis=0):
    return tgt.clone().index_add_(axis, idx, src)
def _segment_sum(src, seg, n):
    out = torch.zeros((n,) + src.shape[1:], dtype=src.dtype)
    return out.index_add_(0, seg, src)
def _pad(x, pw):
    flat = tuple(v for pair in reversed(pw) for v in pair)
    return torch.nn.functional.pad(x, flat)

kernel_name = 'concat_heads__sliding_block_cached__gqa_block_cached__decode'

def setup_inputs():

    _w = (lambda a: (lambda t: t.to(torch.bfloat16) if t.is_floating_point() else t)(torch.as_tensor(a)))
    def _A_setup():
        B, Sq, D = 2, 1, 512
        Hq, Hkv, Sk, Dh = 32, 8, 8192, 128
        assert Hq % Hkv == 0, (Hq, Hkv)
        return {
            "x": _w((lambda *s: torch.randn(*s, dtype=torch.bfloat16) * 0.2)(B, Sq, D)),
            "k_cache": _w((lambda *s: torch.randn(*s, dtype=torch.bfloat16) * 3.2)(B, Hkv, Sk, Dh)),
            "v_cache": _w((lambda *s: torch.randn(*s, dtype=torch.bfloat16) * 1.6)(B, Hkv, Sk, Dh)),
            "wq": _w((lambda *s: torch.randn(*s, dtype=torch.bfloat16) * 3.2)(D, Hq * Dh) * (D ** -0.5)),
            "wo": _w((lambda *s: torch.randn(*s, dtype=torch.bfloat16) * 1.6)(Hq * Dh, D) * ((Hq * Dh) ** -0.5)),
        }
    _A_in = _A_setup()

    def _B_setup():
        B, Sq, D = 2, 1, 512
        Hq, Hkv, Sk, Dh = 32, 8, 8192, 128
        assert Hq % Hkv == 0, (Hq, Hkv)
        return {
            "x": _w((lambda *s: torch.randn(*s, dtype=torch.bfloat16) * 0.4)(B, Sq, D)),
            "k_cache": _w((lambda *s: torch.randn(*s, dtype=torch.bfloat16) * 3.2)(B, Hkv, Sk, Dh)),
            "v_cache": _w((lambda *s: torch.randn(*s, dtype=torch.bfloat16) * 0.8)(B, Hkv, Sk, Dh)),
            "wq": _w((lambda *s: torch.randn(*s, dtype=torch.bfloat16) * 3.2)(D, Hq * Dh) * (D ** -0.5)),
            "wo": _w((lambda *s: torch.randn(*s, dtype=torch.bfloat16) * 0.8)(Hq * Dh, D) * ((Hq * Dh) ** -0.5)),
        }
    _B_in = _B_setup()

    return {
        "A_x": _A_in["x"],
        "A_k_cache": _A_in["k_cache"],
        "A_v_cache": _A_in["v_cache"],
        "A_wq": _A_in["wq"],
        "A_wo": _A_in["wo"],
        "B_x": _B_in["x"],
        "B_k_cache": _B_in["k_cache"],
        "B_v_cache": _B_in["v_cache"],
        "B_wq": _B_in["wq"],
        "B_wo": _B_in["wo"],
    }

def reference(A_x, A_k_cache, A_v_cache, A_wq, A_wo, B_x, B_k_cache, B_v_cache, B_wq, B_wo):
    def _A_ref(x, k_cache, v_cache, wq, wo):
        B, Sq, D = x.shape
        Hq, Dh = 32, 128
        Hkv, Sk = k_cache.shape[1], k_cache.shape[2]
        W = min(4096, max(256, Sk // 4))
        rep = Hq // Hkv
        q = (lambda x, *d: x.permute(*d))((x @ wq).reshape(B, Sq, Hq, Dh), 0, 2, 1, 3)
        k = (lambda x, n, axis: torch.repeat_interleave(x, n, dim=axis))(k_cache[:, :, Sk - W:, :], rep, axis=1)
        v = (lambda x, n, axis: torch.repeat_interleave(x, n, dim=axis))(v_cache[:, :, Sk - W:, :], rep, axis=1)
        scores = torch.einsum("bhqd,bhkd->bhqk", q, k) * (Dh ** -0.5)
        p = _softmax(scores, axis=-1)
        o = torch.einsum("bhqk,bhkd->bhqd", p, v)
        return (lambda x, *d: x.permute(*d))(o, 0, 2, 1, 3).reshape(B, Sq, Hq * Dh) @ wo

    def _B_ref(x, k_cache, v_cache, wq, wo):
        B, Sq, D = x.shape
        Hq, Dh = 32, 128
        Hkv = k_cache.shape[1]
        rep = Hq // Hkv
        q = (lambda x, *d: x.permute(*d))((x @ wq).reshape(B, Sq, Hq, Dh), 0, 2, 1, 3)
        k = (lambda x, n, axis: torch.repeat_interleave(x, n, dim=axis))(k_cache, rep, axis=1)
        v = (lambda x, n, axis: torch.repeat_interleave(x, n, dim=axis))(v_cache, rep, axis=1)
        scores = torch.einsum("bhqd,bhkd->bhqk", q, k) * (Dh ** -0.5)
        p = _softmax(scores, axis=-1)
        o = torch.einsum("bhqk,bhkd->bhqd", p, v)
        return (lambda x, *d: x.permute(*d))(o, 0, 2, 1, 3).reshape(B, Sq, Hq * Dh) @ wo

    a = _A_ref(A_x, A_k_cache, A_v_cache, A_wq, A_wo)
    b = _B_ref(B_x, B_k_cache, B_v_cache, B_wq, B_wo)
    return torch.concatenate([a, b], axis=-1)
```

```asm
; @launch grid=(256,1,1) block=(512,1,1) lds=86528
.amdgcn_target "amdgcn-amd-amdhsa--gfx950"
.text
.globl concat_heads__sliding_block_cached__gqa_block_cached__decode_kernel
.p2align 8
.type concat_heads__sliding_block_cached__gqa_block_cached__decode_kernel,@function
concat_heads__sliding_block_cached__gqa_block_cached__decode_kernel:
    s_cmp_ge_u32 s2, 256
    s_cbranch_scc1 L_end
    s_lshr_b32 s3, s2, 3
    s_lshr_b32 s60, s3, 4
    s_mul_i32 s4, s60, 40
    s_add_u32 s6, s0, s4
    s_addc_u32 s7, s1, 0
    s_load_dwordx2 s[52:53], s[6:7], 0
    s_load_dwordx2 s[36:37], s[6:7], 24
    s_sub_u32 s43, s3, s60
    s_cmp_ge_u32 s43, 6
    s_cselect_b32 s64, 1, 0
    s_mul_i32 s4, s64, 40
    s_add_u32 s8, s0, s4
    s_addc_u32 s9, s1, 0
    s_load_dwordx2 s[24:25], s[8:9], 8
    s_load_dwordx2 s[28:29], s[8:9], 16
    s_load_dwordx2 s[32:33], s[0:1], 96
    s_mov_b32 s54, 2048
    s_mov_b32 s55, 0x20000
    s_mov_b32 s38, 4194304
    s_mov_b32 s39, 0x20000
    v_and_b32 v1, 63, v0
    v_lshrrev_b32 v2, 6, v0
    v_lshrrev_b32 v3, 4, v1
    v_readfirstlane_b32 s12, v2
    v_lshlrev_b32 v9, 2, v2
    v_mov_b32 v10, 0
    ds_write_b32 v9, v10 offset:9472
    ds_write_b32 v10, v10 offset:9504
    ds_write_b32 v9, v10 offset:9536
    v_and_b32 v2, 15, v1
    s_and_b32 s8, s2, 7
    v_lshlrev_b32 v6, 16, v3
    v_lshrrev_b32 v7, 3, v2
    v_lshl_add_u32 v6, v7, 15, v6
    v_and_b32 v7, 7, v2
    v_lshl_add_u32 v6, v7, 4, v6
    v_bfe_u32 v7, v2, 1, 1
    v_lshlrev_b32 v7, 10, v7
    v_lshl_add_u32 v7, v3, 4, v7
    v_and_b32 v8, 1, v2
    v_lshl_add_u32 v7, v8, 3, v7
    s_and_b32 s4, s3, 1
    s_lshl_b32 s4, s4, 8
    s_lshl_b32 s5, s12, 5
    s_add_u32 s4, s4, s5
    s_lshl_b32 s5, s4, 1
    s_lshl_b32 s10, s4, 13
    s_bfe_u32 s4, s3, 0x30001
    s_lshl_b32 s20, s8, 3
    s_add_u32 s4, s4, s20
    s_lshl_b32 s4, s4, 7
    s_add_u32 s10, s10, s4
    s_setprio 3
    s_waitcnt lgkmcnt(0)
    buffer_load_dwordx2 v[32:33], v7, s[52:55], s5 offen
    buffer_load_dwordx4 v[48:51], v6, s[36:39], s10 offen nt
    s_add_u32 s10, s10, 8192
    buffer_load_dwordx4 v[52:55], v6, s[36:39], s10 offen nt
    s_add_u32 s10, s10, 8192
    buffer_load_dwordx4 v[56:59], v6, s[36:39], s10 offen nt
    s_add_u32 s10, s10, 8192
    buffer_load_dwordx4 v[60:63], v6, s[36:39], s10 offen nt
    s_barrier
    s_load_dword s68, s[32:33], 0
    s_load_dword s69, s[32:33], 128
    s_load_dwordx2 s[48:49], s[6:7], 32
    s_load_dwordx2 s[56:57], s[0:1], 80
    s_mov_b32 s26, 33554432
    s_mov_b32 s27, 0x20000
    s_mov_b32 s30, 33554432
    s_mov_b32 s31, 0x20000
    s_mov_b32 s34, 1966080
    s_mov_b32 s35, 0x20000
    s_mul_hi_u32 s3, s43, 0x55555556
    s_mul_i32 s4, s3, 3
    s_sub_u32 s66, s43, s4
    s_sub_u32 s5, s3, 2
    s_lshr_b32 s10, s5, 2
    s_and_b32 s5, s5, 3
    s_lshl_b32 s5, s5, 11
    s_cmp_ge_u32 s3, 2
    s_cselect_b32 s10, s10, s3
    s_cselect_b32 s5, s5, 6144
    s_lshl_b32 s10, s10, 3
    s_add_u32 s63, s10, s8
    s_mul_i32 s10, s66, 21
    s_cmp_gt_u32 s66, 0
    s_addc_u32 s10, s10, 0
    s_mul_i32 s4, s12, 3
    s_add_u32 s10, s10, s4
    s_lshl_b32 s10, s10, 5
    s_add_u32 s10, s10, s5
    s_lshl_b32 s10, s10, 8
    s_lshl_b32 s13, s63, 21
    s_add_u32 s13, s13, s10
    v_and_b32 v4, 3, v2
    v_lshlrev_b32 v4, 2, v4
    v_lshrrev_b32 v5, 2, v2
    v_add_u32 v4, v4, v5
    v_lshlrev_b32 v4, 8, v4
    v_lshl_add_u32 v4, v3, 4, v4
    v_lshlrev_b32 v5, 4, v1
    s_lshr_b32 s3, s2, 3
    s_and_b32 s3, s3, 15
    s_cmp_eq_u32 s3, 15
    s_cselect_b32 s9, 1, 0
    v_mov_b32 v122, 0
    v_mov_b32 v123, 0
    s_cmp_lg_u32 s9, 0
    s_cbranch_scc1 L_light
    s_cmp_eq_u32 s12, 7
    s_cbranch_scc1 L_light
    s_setprio 2
    s_mov_b32 s50, 4194304
    s_mov_b32 s51, 0x20000
    s_mov_b32 s58, 4096
    s_mov_b32 s59, 0x20000
    s_mov_b32 s40, 0x5040100
    s_mov_b32 s41, 0x7060302
    s_mov_b32 s42, 0x3e0293ee
    s_lshr_b32 s61, s2, 5
    s_and_b32 s61, s61, 3
    s_lshl_b32 s4, s8, 2
    s_add_u32 s61, s61, s4
    s_bfe_u32 s62, s2, 0x20003
    s_mul_i32 s11, s8, 30
    s_add_u32 s11, s11, s43
    s_lshl_b32 s67, s11, 11
    s_add_u32 s67, s67, 139264
    s_lshl_b32 s20, s61, 7
    s_lshl_b32 s21, s12, 4
    s_add_u32 s20, s20, s21
    s_lshl_b32 s20, s20, 10
    s_lshl_b32 s21, s62, 8
    s_add_u32 s7, s20, s21
    s_lshl_b32 s21, s60, 2
    s_add_u32 s21, s21, s62
    s_lshl_b32 s21, s21, 5
    s_add_u32 s21, s21, s61
    s_lshl_b32 s21, s21, 11
    s_lshl_b32 s20, s12, 7
    s_add_u32 s21, s21, s20
    s_add_u32 s6, s21, 630784
    s_and_b32 s21, s61, 3
    s_lshl_b32 s44, s21, 9
    s_lshl_b32 s20, s12, 6
    s_add_u32 s44, s44, s20
    s_add_u32 s44, s44, 1318912
    v_lshrrev_b32 v8, 5, v0
    v_mul_u32_u24 v8, 144, v8
    v_and_b32 v9, 31, v0
    v_lshl_add_u32 v8, v9, 2, v8
    v_and_b32 v9, 3, v1
    v_lshlrev_b32 v9, 9, v9
    v_lshl_add_u32 v9, v3, 4, v9
    s_lshl_b32 s20, s12, 6
    v_add_u32 v9, s20, v9
    s_mul_i32 s20, s12, 4112
    v_add_u32 v10, s20, v5
    s_mul_i32 s20, s12, 2304
    v_mul_u32_u24 v16, 144, v2
    v_add_u32 v16, s20, v16
    v_lshrrev_b32 v15, 1, v2
    v_mul_u32_u24 v15, 4112, v15
    v_and_b32 v18, 1, v2
    v_lshl_add_u32 v15, v18, 7, v15
    v_lshl_add_u32 v15, v3, 8, v15
    s_lshr_b32 s20, s12, 1
    s_lshl_b32 s21, s20, 10
    s_and_b32 s22, s12, 1
    s_lshl_b32 s22, s22, 3
    s_add_u32 s21, s21, s22
    v_add_u32 v15, s21, v15
    v_bfe_u32 v18, v2, 2, 1
    v_lshlrev_b32 v14, 8, v18
    v_lshl_add_u32 v14, v3, 4, v14
    s_lshl_b32 s20, s20, 6
    s_add_u32 s20, s20, s22
    v_add_u32 v11, s20, v14
    v_and_b32 v19, 3, v2
    v_lshrrev_b32 v24, 3, v2
    v_lshl_add_u32 v19, v24, 2, v19
    s_cmp_eq_u32 s60, 0
    s_cselect_b32 s22, 3, 12
    s_cselect_b32 s23, 0, 6
    s_mul_i32 s21, s8, 30
    s_add_u32 s23, s23, s21
    v_mul_lo_u32 v18, v18, s22
    v_add_u32 v18, s23, v18
    v_add_u32 v18, v18, v19
    v_cmp_gt_u32 s[46:47], s22, v19
    v_add_u32 v19, 8, v19
    v_cmp_gt_u32 s[14:15], s22, v19
    v_lshlrev_b32 v12, 11, v18
    v_lshl_add_u32 v12, v3, 4, v12
    v_mov_b32 v19, 0x80000000
    v_add_u32 v13, 0x4000, v12
    v_cndmask_b32 v12, v19, v12, s[46:47]
    v_cndmask_b32 v13, v19, v13, s[14:15]
    v_lshlrev_b32 v17, 10, v3
    v_lshrrev_b32 v19, 1, v2
    v_lshl_add_u32 v17, v19, 4, v17
    v_lshlrev_b32 v19, 4, v0
    v_add_u32 v19, 61952, v19
    ds_write_b128 v19, v[8:11]
    ds_write_b128 v19, v[12:15] offset:8192
    ds_write_b64 v19, v[16:17] offset:16384
    s_waitcnt vmcnt(0)
    s_setprio 3
    s_add_u32 s20, s13, 0
    buffer_load_dwordx4 a[0:3], v5, s[24:27], s20 offen offset:0 nt
    buffer_load_dwordx4 a[4:7], v5, s[24:27], s20 offen offset:1024 nt
    buffer_load_dwordx4 a[8:11], v5, s[24:27], s20 offen offset:2048 nt
    buffer_load_dwordx4 a[12:15], v5, s[24:27], s20 offen offset:3072 nt
    v_perm_b32 v34, v52, v48, s40
    v_perm_b32 v35, v60, v56, s40
    v_perm_b32 v36, v52, v48, s41
    v_perm_b32 v37, v60, v56, s41
    v_mfma_f32_16x16x16_bf16 v[64:67], v[34:35], v[32:33], 0
    v_perm_b32 v38, v53, v49, s40
    v_perm_b32 v39, v61, v57, s40
    v_mfma_f32_16x16x16_bf16 v[68:71], v[36:37], v[32:33], 0
    v_perm_b32 v40, v53, v49, s41
    v_perm_b32 v41, v61, v57, s41
    v_mfma_f32_16x16x16_bf16 v[72:75], v[38:39], v[32:33], 0
    v_perm_b32 v34, v54, v50, s40
    v_perm_b32 v35, v62, v58, s40
    v_mfma_f32_16x16x16_bf16 v[76:79], v[40:41], v[32:33], 0
    v_perm_b32 v36, v54, v50, s41
    v_perm_b32 v37, v62, v58, s41
    v_mfma_f32_16x16x16_bf16 v[80:83], v[34:35], v[32:33], 0
    v_perm_b32 v38, v55, v51, s40
    v_perm_b32 v39, v63, v59, s40
    v_mfma_f32_16x16x16_bf16 v[84:87], v[36:37], v[32:33], 0
    v_perm_b32 v40, v55, v51, s41
    v_perm_b32 v41, v63, v59, s41
    v_mfma_f32_16x16x16_bf16 v[88:91], v[38:39], v[32:33], 0
    v_and_b32 v8, 1, v2
    v_lshlrev_b32 v8, 9, v8
    v_mfma_f32_16x16x16_bf16 v[92:95], v[40:41], v[32:33], 0
    v_bfe_u32 v9, v2, 1, 1
    v_lshl_add_u32 v8, v9, 8, v8
    v_and_b32 v9, 1, v3
    v_lshl_add_u32 v8, v9, 7, v8
    s_lshl_b32 s20, s12, 10
    v_add_u32 v8, s20, v8
    s_mov_b32 s20, 0x00050005
    s_mov_b32 s21, 0x000a000a
    s_waitcnt lgkmcnt(0)
    s_mov_b64 exec, s[20:21]
    ds_write2_b32 v8, v64, v65 offset0:0 offset1:8
    ds_write2_b32 v8, v66, v67 offset0:16 offset1:24
    ds_write2_b32 v8, v68, v69 offset0:1 offset1:9
    ds_write2_b32 v8, v70, v71 offset0:17 offset1:25
    ds_write2_b32 v8, v72, v73 offset0:2 offset1:10
    ds_write2_b32 v8, v74, v75 offset0:18 offset1:26
    ds_write2_b32 v8, v76, v77 offset0:3 offset1:11
    ds_write2_b32 v8, v78, v79 offset0:19 offset1:27
    s_waitcnt lgkmcnt(4)
    ds_write2_b32 v8, v80, v81 offset0:4 offset1:12
    ds_write2_b32 v8, v82, v83 offset0:20 offset1:28
    ds_write2_b32 v8, v84, v85 offset0:5 offset1:13
    ds_write2_b32 v8, v86, v87 offset0:21 offset1:29
    ds_write2_b32 v8, v88, v89 offset0:6 offset1:14
    ds_write2_b32 v8, v90, v91 offset0:22 offset1:30
    ds_write2_b32 v8, v92, v93 offset0:7 offset1:15
    ds_write2_b32 v8, v94, v95 offset0:23 offset1:31
    s_mov_b64 exec, -1
    s_waitcnt lgkmcnt(0)
    s_cmp_eq_u32 s60, 0
    s_cselect_b32 s16, s68, s69
    s_cmp_eq_u32 s64, 0
    s_cselect_b32 s18, s68, s69
    s_add_u32 s16, s16, 1
    s_add_u32 s18, s18, 1
    s_xor_b32 s17, s16, 0x5bd1e995
    s_xor_b32 s19, s18, 0x5bd1e995
    s_lshl_b32 s45, s17, 24
    s_lshl_b32 s20, s12, 2
    v_mov_b32 v8, s20
    v_mov_b32 v9, 1
    s_mov_b64 exec, 1
    ds_write_b32 v8, v9 offset:9472
    s_mov_b64 exec, -1
    s_setprio 2
    s_add_u32 s20, s13, 4096
    buffer_load_dwordx4 a[16:19], v5, s[24:27], s20 offen offset:0 nt
    buffer_load_dwordx4 a[20:23], v5, s[24:27], s20 offen offset:1024 nt
    buffer_load_dwordx4 a[24:27], v5, s[24:27], s20 offen offset:2048 nt
    buffer_load_dwordx4 a[28:31], v5, s[24:27], s20 offen offset:3072 nt
    s_add_u32 s20, s13, 8192
    buffer_load_dwordx4 a[32:35], v5, s[24:27], s20 offen offset:0 nt
    buffer_load_dwordx4 a[36:39], v5, s[24:27], s20 offen offset:1024 nt
    buffer_load_dwordx4 a[40:43], v5, s[24:27], s20 offen offset:2048 nt
    buffer_load_dwordx4 a[44:47], v5, s[24:27], s20 offen offset:3072 nt
    s_add_u32 s20, s13, 12288
    buffer_load_dwordx4 a[48:51], v5, s[24:27], s20 offen offset:0 nt
    buffer_load_dwordx4 a[52:55], v5, s[24:27], s20 offen offset:1024 nt
    buffer_load_dwordx4 a[56:59], v5, s[24:27], s20 offen offset:2048 nt
    buffer_load_dwordx4 a[60:63], v5, s[24:27], s20 offen offset:3072 nt
    s_add_u32 s20, s13, 16384
    buffer_load_dwordx4 a[64:67], v5, s[24:27], s20 offen offset:0 nt
    buffer_load_dwordx4 a[68:71], v5, s[24:27], s20 offen offset:1024 nt
    buffer_load_dwordx4 a[72:75], v5, s[24:27], s20 offen offset:2048 nt
    buffer_load_dwordx4 a[76:79], v5, s[24:27], s20 offen offset:3072 nt
    s_add_u32 s20, s13, 20480
    buffer_load_dwordx4 a[80:83], v5, s[24:27], s20 offen offset:0 nt
    buffer_load_dwordx4 a[84:87], v5, s[24:27], s20 offen offset:1024 nt
    buffer_load_dwordx4 a[88:91], v5, s[24:27], s20 offen offset:2048 nt
    buffer_load_dwordx4 a[92:95], v5, s[24:27], s20 offen offset:3072 nt
    s_setprio 1
    s_lshl_b32 s20, s12, 12
    s_add_u32 s20, s20, 28672
    v_lshlrev_b32 v56, 2, v3
    v_lshlrev_b32 v57, 8, v2
    v_add_u32 v57, s20, v57
    v_or_b32 v58, 0, v56
    v_xor_b32 v59, v58, v2
    v_lshlrev_b32 v59, 4, v59
    v_lshl_add_u32 v59, v58, 8, v59
    v_add_u32 v48, s20, v59
    v_or_b32 v58, 1, v56
    v_xor_b32 v59, v58, v2
    v_lshlrev_b32 v59, 4, v59
    v_lshl_add_u32 v59, v58, 8, v59
    v_add_u32 v49, s20, v59
    v_or_b32 v58, 2, v56
    v_xor_b32 v59, v58, v2
    v_lshlrev_b32 v59, 4, v59
    v_lshl_add_u32 v59, v58, 8, v59
    v_add_u32 v50, s20, v59
    v_or_b32 v58, 3, v56
    v_xor_b32 v59, v58, v2
    v_lshlrev_b32 v59, 4, v59
    v_lshl_add_u32 v59, v58, 8, v59
    v_add_u32 v51, s20, v59
    v_or_b32 v58, 0, v3
    v_xor_b32 v58, v58, v2
    v_lshl_add_u32 v52, v58, 4, v57
    v_or_b32 v58, 4, v3
    v_xor_b32 v58, v58, v2
    v_lshl_add_u32 v53, v58, 4, v57
    v_or_b32 v58, 8, v3
    v_xor_b32 v58, v58, v2
    v_lshl_add_u32 v54, v58, 4, v57
    v_or_b32 v58, 12, v3
    v_xor_b32 v58, v58, v2
    v_lshl_add_u32 v55, v58, 4, v57
    s_cmp_ge_u32 s12, 4
    s_cbranch_scc1 L_yq
    s_add_u32 s20, s13, 0
    buffer_load_dwordx4 v[64:67], v5, s[28:31], s20 offen offset:0 nt
    buffer_load_dwordx4 v[68:71], v5, s[28:31], s20 offen offset:1024 nt
    buffer_load_dwordx4 v[72:75], v5, s[28:31], s20 offen offset:2048 nt
    buffer_load_dwordx4 v[76:79], v5, s[28:31], s20 offen offset:3072 nt
    s_add_u32 s20, s13, 4096
    buffer_load_dwordx4 v[80:83], v5, s[28:31], s20 offen offset:0 nt
    buffer_load_dwordx4 v[84:87], v5, s[28:31], s20 offen offset:1024 nt
    buffer_load_dwordx4 v[88:91], v5, s[28:31], s20 offen offset:2048 nt
    buffer_load_dwordx4 v[92:95], v5, s[28:31], s20 offen offset:3072 nt
    s_waitcnt vmcnt(28)
    ds_write_b128 v48, a[0:3]
    ds_write_b128 v49, a[4:7]
    ds_write_b128 v50, a[8:11]
    ds_write_b128 v51, a[12:15]
    ds_read_b128 a[0:3], v52
    ds_read_b128 a[4:7], v53
    ds_read_b128 a[8:11], v54
    ds_read_b128 a[12:15], v55
    s_waitcnt vmcnt(24)
    ds_write_b128 v48, a[16:19]
    ds_write_b128 v49, a[20:23]
    ds_write_b128 v50, a[24:27]
    ds_write_b128 v51, a[28:31]
    s_waitcnt lgkmcnt(8)
    ds_read_b128 a[16:19], v52
    ds_read_b128 a[20:23], v53
    ds_read_b128 a[24:27], v54
    ds_read_b128 a[28:31], v55
    s_add_u32 s20, s13, 8192
    buffer_load_dwordx4 v[96:99], v5, s[28:31], s20 offen offset:0 nt
    buffer_load_dwordx4 v[100:103], v5, s[28:31], s20 offen offset:1024 nt
    buffer_load_dwordx4 v[104:107], v5, s[28:31], s20 offen offset:2048 nt
    buffer_load_dwordx4 v[108:111], v5, s[28:31], s20 offen offset:3072 nt
    s_add_u32 s20, s13, 12288
    buffer_load_dwordx4 v[112:115], v5, s[28:31], s20 offen offset:0 nt
    buffer_load_dwordx4 v[116:119], v5, s[28:31], s20 offen offset:1024 nt
    buffer_load_dwordx4 v[120:123], v5, s[28:31], s20 offen offset:2048 nt
    buffer_load_dwordx4 v[124:127], v5, s[28:31], s20 offen offset:3072 nt
    s_waitcnt lgkmcnt(0)
    s_waitcnt vmcnt(28)
    ds_write_b128 v48, a[32:35]
    ds_write_b128 v49, a[36:39]
    ds_write_b128 v50, a[40:43]
    ds_write_b128 v51, a[44:47]
    ds_read_b128 a[32:35], v52
    ds_read_b128 a[36:39], v53
    ds_read_b128 a[40:43], v54
    ds_read_b128 a[44:47], v55
    s_waitcnt vmcnt(24)
    ds_write_b128 v48, a[48:51]
    ds_write_b128 v49, a[52:55]
    ds_write_b128 v50, a[56:59]
    ds_write_b128 v51, a[60:63]
    s_waitcnt lgkmcnt(8)
    ds_read_b128 a[48:51], v52
    ds_read_b128 a[52:55], v53
    ds_read_b128 a[56:59], v54
    ds_read_b128 a[60:63], v55
    s_add_u32 s20, s13, 16384
    buffer_load_dwordx4 v[128:131], v5, s[28:31], s20 offen offset:0 nt
    buffer_load_dwordx4 v[132:135], v5, s[28:31], s20 offen offset:1024 nt
    buffer_load_dwordx4 v[136:139], v5, s[28:31], s20 offen offset:2048 nt
    buffer_load_dwordx4 v[140:143], v5, s[28:31], s20 offen offset:3072 nt
    s_add_u32 s20, s13, 20480
    buffer_load_dwordx4 v[144:147], v5, s[28:31], s20 offen offset:0 nt
    buffer_load_dwordx4 v[148:151], v5, s[28:31], s20 offen offset:1024 nt
    buffer_load_dwordx4 v[152:155], v5, s[28:31], s20 offen offset:2048 nt
    buffer_load_dwordx4 v[156:159], v5, s[28:31], s20 offen offset:3072 nt
    s_waitcnt lgkmcnt(0)
    s_waitcnt vmcnt(28)
    ds_write_b128 v48, a[64:67]
    ds_write_b128 v49, a[68:71]
    ds_write_b128 v50, a[72:75]
    ds_write_b128 v51, a[76:79]
    ds_read_b128 a[64:67], v52
    ds_read_b128 a[68:71], v53
    ds_read_b128 a[72:75], v54
    ds_read_b128 a[76:79], v55
    s_waitcnt vmcnt(24)
    ds_write_b128 v48, a[80:83]
    ds_write_b128 v49, a[84:87]
    ds_write_b128 v50, a[88:91]
    ds_write_b128 v51, a[92:95]
    s_waitcnt lgkmcnt(8)
    ds_read_b128 a[80:83], v52
    ds_read_b128 a[84:87], v53
    ds_read_b128 a[88:91], v54
    ds_read_b128 a[92:95], v55
    s_mov_b32 s65, 5000750
    v_mov_b32 v6, 0
L_wq1:
    ds_read_b32 v7, v6 offset:9504
    s_waitcnt lgkmcnt(0)
    v_cmp_ne_u32 vcc, 1, v7
    s_nop 4
    s_cbranch_vccz L_wqok1
    s_sub_u32 s65, s65, 1
    s_cmp_lg_u32 s65, 0
    s_cbranch_scc1 L_wq1
    s_branch L_end
L_wqok1:
    v_and_b32 v6, 3, v2
    v_lshlrev_b32 v6, 8, v6
    v_lshl_add_u32 v6, v3, 4, v6
    ds_read_b128 v[32:35], v6 offset:8192
    ds_read_b128 v[36:39], v6 offset:8256
    ds_read_b128 v[40:43], v6 offset:8320
    ds_read_b128 v[44:47], v6 offset:8384
    s_waitcnt lgkmcnt(0)
    v_mfma_f32_16x16x32_bf16 v[8:11], a[0:3], v[32:35], 0
    v_mfma_f32_16x16x32_bf16 v[8:11], a[4:7], v[36:39], v[8:11]
    v_mfma_f32_16x16x32_bf16 v[8:11], a[8:11], v[40:43], v[8:11]
    v_mfma_f32_16x16x32_bf16 v[8:11], a[12:15], v[44:47], v[8:11]
    v_mfma_f32_16x16x32_bf16 v[12:15], a[16:19], v[32:35], 0
    v_mfma_f32_16x16x32_bf16 v[12:15], a[20:23], v[36:39], v[12:15]
    v_mfma_f32_16x16x32_bf16 v[12:15], a[24:27], v[40:43], v[12:15]
    v_mfma_f32_16x16x32_bf16 v[12:15], a[28:31], v[44:47], v[12:15]
    v_mfma_f32_16x16x32_bf16 v[16:19], a[32:35], v[32:35], 0
    v_mfma_f32_16x16x32_bf16 v[16:19], a[36:39], v[36:39], v[16:19]
    v_mfma_f32_16x16x32_bf16 v[16:19], a[40:43], v[40:43], v[16:19]
    v_mfma_f32_16x16x32_bf16 v[16:19], a[44:47], v[44:47], v[16:19]
    v_mfma_f32_16x16x32_bf16 v[20:23], a[48:51], v[32:35], 0
    v_mfma_f32_16x16x32_bf16 v[20:23], a[52:55], v[36:39], v[20:23]
    v_mfma_f32_16x16x32_bf16 v[20:23], a[56:59], v[40:43], v[20:23]
    v_mfma_f32_16x16x32_bf16 v[20:23], a[60:63], v[44:47], v[20:23]
    v_mfma_f32_16x16x32_bf16 v[24:27], a[64:67], v[32:35], 0
    v_mfma_f32_16x16x32_bf16 v[24:27], a[68:71], v[36:39], v[24:27]
    v_mfma_f32_16x16x32_bf16 v[24:27], a[72:75], v[40:43], v[24:27]
    v_mfma_f32_16x16x32_bf16 v[24:27], a[76:79], v[44:47], v[24:27]
    v_mfma_f32_16x16x32_bf16 v[28:31], a[80:83], v[32:35], 0
    v_mfma_f32_16x16x32_bf16 v[28:31], a[84:87], v[36:39], v[28:31]
    v_mfma_f32_16x16x32_bf16 v[28:31], a[88:91], v[40:43], v[28:31]
    v_mfma_f32_16x16x32_bf16 v[28:31], a[92:95], v[44:47], v[28:31]
    s_nop 7
    s_lshl_b32 s20, s12, 4
    v_lshlrev_b32 v7, 2, v1
    v_add_u32 v7, s20, v7
    v_max3_f32 v44, v8, v9, v10
    v_max3_f32 v32, v11, v12, v13
    v_max3_f32 v44, v44, v14, v15
    v_max3_f32 v32, v32, v16, v17
    v_max3_f32 v44, v44, v18, v19
    v_max3_f32 v32, v32, v20, v21
    v_max3_f32 v44, v44, v22, v23
    v_max3_f32 v32, v32, v24, v25
    v_max3_f32 v44, v44, v26, v27
    v_max3_f32 v32, v32, v28, v29
    v_max3_f32 v44, v44, v30, v31
    v_max_f32 v44, v44, v32
    v_mov_b32 v32, v44
    s_nop 1
    v_permlane32_swap_b32 v44, v32
    v_max_f32 v44, v44, v32
    v_mov_b32 v32, v44
    s_nop 1
    v_permlane16_swap_b32 v44, v32
    v_max_f32 v44, v44, v32
    v_mul_f32 v32, s42, v44
    v_fma_f32 v8, v8, s42, -v32
    v_fma_f32 v9, v9, s42, -v32
    v_fma_f32 v10, v10, s42, -v32
    v_fma_f32 v11, v11, s42, -v32
    v_fma_f32 v12, v12, s42, -v32
    v_fma_f32 v13, v13, s42, -v32
    v_fma_f32 v14, v14, s42, -v32
    v_fma_f32 v15, v15, s42, -v32
    v_fma_f32 v16, v16, s42, -v32
    v_fma_f32 v17, v17, s42, -v32
    v_fma_f32 v18, v18, s42, -v32
    v_fma_f32 v19, v19, s42, -v32
    v_fma_f32 v20, v20, s42, -v32
    v_fma_f32 v21, v21, s42, -v32
    v_fma_f32 v22, v22, s42, -v32
    v_fma_f32 v23, v23, s42, -v32
    v_fma_f32 v24, v24, s42, -v32
    v_fma_f32 v25, v25, s42, -v32
    v_fma_f32 v26, v26, s42, -v32
    v_fma_f32 v27, v27, s42, -v32
    v_fma_f32 v28, v28, s42, -v32
    v_fma_f32 v29, v29, s42, -v32
    v_fma_f32 v30, v30, s42, -v32
    v_fma_f32 v31, v31, s42, -v32
    v_exp_f32 v8, v8
    v_exp_f32 v9, v9
    v_exp_f32 v10, v10
    v_exp_f32 v11, v11
    v_exp_f32 v12, v12
    v_exp_f32 v13, v13
    v_exp_f32 v14, v14
    v_exp_f32 v15, v15
    v_exp_f32 v16, v16
    v_exp_f32 v17, v17
    v_exp_f32 v18, v18
    v_exp_f32 v19, v19
    v_exp_f32 v20, v20
    v_exp_f32 v21, v21
    v_exp_f32 v22, v22
    v_exp_f32 v23, v23
    v_exp_f32 v24, v24
    v_exp_f32 v25, v25
    v_exp_f32 v26, v26
    v_exp_f32 v27, v27
    v_exp_f32 v28, v28
    v_exp_f32 v29, v29
    v_exp_f32 v30, v30
    v_exp_f32 v31, v31
    v_pk_add_f32 v[34:35], v[8:9], v[10:11]
    v_pk_add_f32 v[36:37], v[12:13], v[14:15]
    v_pk_add_f32 v[34:35], v[34:35], v[16:17]
    v_pk_add_f32 v[36:37], v[36:37], v[18:19]
    v_pk_add_f32 v[34:35], v[34:35], v[20:21]
    v_pk_add_f32 v[36:37], v[36:37], v[22:23]
    v_pk_add_f32 v[34:35], v[34:35], v[24:25]
    v_pk_add_f32 v[36:37], v[36:37], v[26:27]
    v_pk_add_f32 v[34:35], v[34:35], v[28:29]
    v_pk_add_f32 v[36:37], v[36:37], v[30:31]
    v_pk_add_f32 v[34:35], v[34:35], v[36:37]
    v_cvt_pk_bf16_f32 v8, v8, v9
    v_cvt_pk_bf16_f32 v9, v10, v11
    v_cvt_pk_bf16_f32 v10, v12, v13
    v_cvt_pk_bf16_f32 v11, v14, v15
    v_cvt_pk_bf16_f32 v12, v16, v17
    v_cvt_pk_bf16_f32 v13, v18, v19
    v_cvt_pk_bf16_f32 v14, v20, v21
    v_cvt_pk_bf16_f32 v15, v22, v23
    v_cvt_pk_bf16_f32 v16, v24, v25
    v_cvt_pk_bf16_f32 v17, v26, v27
    v_cvt_pk_bf16_f32 v18, v28, v29
    v_cvt_pk_bf16_f32 v19, v30, v31
    v_add_f32 v45, v34, v35
    v_mov_b32 v33, v45
    s_nop 1
    v_permlane32_swap_b32 v45, v33
    v_add_f32 v45, v45, v33
    v_mov_b32 v33, v45
    s_nop 1
    v_permlane16_swap_b32 v45, v33
    v_add_f32 v45, v45, v33
    s_mov_b64 exec, 0xf
    ds_write_b32 v7, v44 offset:9216
    ds_write_b32 v7, v45 offset:9344
    s_mov_b64 exec, -1
    s_lshl_b32 s20, s12, 2
    v_mov_b32 v6, s20
    v_mov_b32 v7, 1
    s_waitcnt lgkmcnt(0)
    ds_write_b32 v6, v7 offset:9536
    v_lshlrev_b32 v6, 4, v0
    v_add_u32 v6, 61952, v6
    ds_read_b128 v[20:23], v6
    ds_read_b128 v[24:27], v6 offset:8192
    ds_read_b64 v[28:29], v6 offset:16384
    s_waitcnt vmcnt(16)
    v_perm_b32 v32, v68, v64, s40
    v_perm_b32 v33, v76, v72, s40
    v_perm_b32 v34, v84, v80, s40
    v_perm_b32 v35, v92, v88, s40
    v_perm_b32 v36, v68, v64, s41
    v_perm_b32 v37, v76, v72, s41
    v_perm_b32 v38, v84, v80, s41
    v_perm_b32 v39, v92, v88, s41
    v_mfma_f32_16x16x32_bf16 a[0:3], v[8:11], v[32:35], 0
    v_perm_b32 v40, v69, v65, s40
    v_perm_b32 v41, v77, v73, s40
    v_perm_b32 v42, v85, v81, s40
    v_perm_b32 v43, v93, v89, s40
    v_mfma_f32_16x16x32_bf16 a[4:7], v[8:11], v[36:39], 0
    v_perm_b32 v44, v69, v65, s41
    v_perm_b32 v45, v77, v73, s41
    v_perm_b32 v46, v85, v81, s41
    v_perm_b32 v47, v93, v89, s41
    v_mfma_f32_16x16x32_bf16 a[8:11], v[8:11], v[40:43], 0
    v_perm_b32 v32, v70, v66, s40
    v_perm_b32 v33, v78, v74, s40
    v_perm_b32 v34, v86, v82, s40
    v_perm_b32 v35, v94, v90, s40
    v_mfma_f32_16x16x32_bf16 a[12:15], v[8:11], v[44:47], 0
    v_perm_b32 v36, v70, v66, s41
    v_perm_b32 v37, v78, v74, s41
    v_perm_b32 v38, v86, v82, s41
    v_perm_b32 v39, v94, v90, s41
    v_mfma_f32_16x16x32_bf16 a[16:19], v[8:11], v[32:35], 0
    v_perm_b32 v40, v71, v67, s40
    v_perm_b32 v41, v79, v75, s40
    v_perm_b32 v42, v87, v83, s40
    v_perm_b32 v43, v95, v91, s40
    v_mfma_f32_16x16x32_bf16 a[20:23], v[8:11], v[36:39], 0
    v_perm_b32 v44, v71, v67, s41
    v_perm_b32 v45, v79, v75, s41
    v_perm_b32 v46, v87, v83, s41
    v_perm_b32 v47, v95, v91, s41
    v_mfma_f32_16x16x32_bf16 a[24:27], v[8:11], v[40:43], 0
    s_nop 1
    v_mfma_f32_16x16x32_bf16 a[28:31], v[8:11], v[44:47], 0
    s_waitcnt vmcnt(8)
    v_perm_b32 v32, v100, v96, s40
    v_perm_b32 v33, v108, v104, s40
    v_perm_b32 v34, v116, v112, s40
    v_perm_b32 v35, v124, v120, s40
    v_perm_b32 v36, v100, v96, s41
    v_perm_b32 v37, v108, v104, s41
    v_perm_b32 v38, v116, v112, s41
    v_perm_b32 v39, v124, v120, s41
    v_mfma_f32_16x16x32_bf16 a[0:3], v[12:15], v[32:35], a[0:3]
    v_perm_b32 v40, v101, v97, s40
    v_perm_b32 v41, v109, v105, s40
    v_perm_b32 v42, v117, v113, s40
    v_perm_b32 v43, v125, v121, s40
    v_mfma_f32_16x16x32_bf16 a[4:7], v[12:15], v[36:39], a[4:7]
    v_perm_b32 v44, v101, v97, s41
    v_perm_b32 v45, v109, v105, s41
    v_perm_b32 v46, v117, v113, s41
    v_perm_b32 v47, v125, v121, s41
    v_mfma_f32_16x16x32_bf16 a[8:11], v[12:15], v[40:43], a[8:11]
    v_perm_b32 v32, v102, v98, s40
    v_perm_b32 v33, v110, v106, s40
    v_perm_b32 v34, v118, v114, s40
    v_perm_b32 v35, v126, v122, s40
    v_mfma_f32_16x16x32_bf16 a[12:15], v[12:15], v[44:47], a[12:15]
    v_perm_b32 v36, v102, v98, s41
    v_perm_b32 v37, v110, v106, s41
    v_perm_b32 v38, v118, v114, s41
    v_perm_b32 v39, v126, v122, s41
    v_mfma_f32_16x16x32_bf16 a[16:19], v[12:15], v[32:35], a[16:19]
    v_perm_b32 v40, v103, v99, s40
    v_perm_b32 v41, v111, v107, s40
    v_perm_b32 v42, v119, v115, s40
    v_perm_b32 v43, v127, v123, s40
    v_mfma_f32_16x16x32_bf16 a[20:23], v[12:15], v[36:39], a[20:23]
    v_perm_b32 v44, v103, v99, s41
    v_perm_b32 v45, v111, v107, s41
    v_perm_b32 v46, v119, v115, s41
    v_perm_b32 v47, v127, v123, s41
    v_mfma_f32_16x16x32_bf16 a[24:27], v[12:15], v[40:43], a[24:27]
    s_nop 1
    v_mfma_f32_16x16x32_bf16 a[28:31], v[12:15], v[44:47], a[28:31]
    s_waitcnt vmcnt(0)
    v_perm_b32 v32, v132, v128, s40
    v_perm_b32 v33, v140, v136, s40
    v_perm_b32 v34, v148, v144, s40
    v_perm_b32 v35, v156, v152, s40
    v_perm_b32 v36, v132, v128, s41
    v_perm_b32 v37, v140, v136, s41
    v_perm_b32 v38, v148, v144, s41
    v_perm_b32 v39, v156, v152, s41
    v_mfma_f32_16x16x32_bf16 a[0:3], v[16:19], v[32:35], a[0:3]
    v_perm_b32 v40, v133, v129, s40
    v_perm_b32 v41, v141, v137, s40
    v_perm_b32 v42, v149, v145, s40
    v_perm_b32 v43, v157, v153, s40
    v_mfma_f32_16x16x32_bf16 a[4:7], v[16:19], v[36:39], a[4:7]
    v_perm_b32 v44, v133, v129, s41
    v_perm_b32 v45, v141, v137, s41
    v_perm_b32 v46, v149, v145, s41
    v_perm_b32 v47, v157, v153, s41
    v_mfma_f32_16x16x32_bf16 a[8:11], v[16:19], v[40:43], a[8:11]
    v_perm_b32 v32, v134, v130, s40
    v_perm_b32 v33, v142, v138, s40
    v_perm_b32 v34, v150, v146, s40
    v_perm_b32 v35, v158, v154, s40
    v_mfma_f32_16x16x32_bf16 a[12:15], v[16:19], v[44:47], a[12:15]
    v_perm_b32 v36, v134, v130, s41
    v_perm_b32 v37, v142, v138, s41
    v_perm_b32 v38, v150, v146, s41
    v_perm_b32 v39, v158, v154, s41
    v_mfma_f32_16x16x32_bf16 a[16:19], v[16:19], v[32:35], a[16:19]
    v_perm_b32 v40, v135, v131, s40
    v_perm_b32 v41, v143, v139, s40
    v_perm_b32 v42, v151, v147, s40
    v_perm_b32 v43, v159, v155, s40
    v_mfma_f32_16x16x32_bf16 a[20:23], v[16:19], v[36:39], a[20:23]
    v_perm_b32 v44, v135, v131, s41
    v_perm_b32 v45, v143, v139, s41
    v_perm_b32 v46, v151, v147, s41
    v_perm_b32 v47, v159, v155, s41
    v_mfma_f32_16x16x32_bf16 a[24:27], v[16:19], v[40:43], a[24:27]
    s_nop 1
    v_mfma_f32_16x16x32_bf16 a[28:31], v[16:19], v[44:47], a[28:31]
    s_setprio 0
    v_lshlrev_b32 v6, 12, v3
    v_lshl_add_u32 v6, v2, 4, v6
    buffer_load_dwordx4 v[48:51], v6, s[48:51], s7 offen offset:0 nt
    buffer_load_dwordx4 v[52:55], v6, s[48:51], s7 offen offset:1024 nt
    buffer_load_dwordx4 v[56:59], v6, s[48:51], s7 offen offset:2048 nt
    buffer_load_dwordx4 v[60:63], v6, s[48:51], s7 offen offset:3072 nt
    s_nop 4
    s_waitcnt lgkmcnt(0)
    s_mov_b64 exec, 0xffff
    ds_write_b128 v28, a[0:3] offset:10240
    ds_write_b128 v28, a[4:7] offset:10256
    ds_write_b128 v28, a[8:11] offset:10272
    ds_write_b128 v28, a[12:15] offset:10288
    ds_write_b128 v28, a[16:19] offset:10304
    ds_write_b128 v28, a[20:23] offset:10320
    ds_write_b128 v28, a[24:27] offset:10336
    s_nop 1
    ds_write_b128 v28, a[28:31] offset:10352
    s_mov_b64 exec, -1
    s_waitcnt lgkmcnt(0)
    s_branch L_D
L_yq:
    s_waitcnt vmcnt(20)
    ds_write_b128 v48, a[0:3]
    ds_write_b128 v49, a[4:7]
    ds_write_b128 v50, a[8:11]
    ds_write_b128 v51, a[12:15]
    ds_read_b128 a[0:3], v52
    ds_read_b128 a[4:7], v53
    ds_read_b128 a[8:11], v54
    ds_read_b128 a[12:15], v55
    s_waitcnt vmcnt(16)
    ds_write_b128 v48, a[16:19]
    ds_write_b128 v49, a[20:23]
    ds_write_b128 v50, a[24:27]
    ds_write_b128 v51, a[28:31]
    s_waitcnt lgkmcnt(8)
    ds_read_b128 a[16:19], v52
    ds_read_b128 a[20:23], v53
    ds_read_b128 a[24:27], v54
    ds_read_b128 a[28:31], v55
    s_waitcnt lgkmcnt(0)
    s_waitcnt vmcnt(12)
    ds_write_b128 v48, a[32:35]
    ds_write_b128 v49, a[36:39]
    ds_write_b128 v50, a[40:43]
    ds_write_b128 v51, a[44:47]
    ds_read_b128 a[32:35], v52
    ds_read_b128 a[36:39], v53
    ds_read_b128 a[40:43], v54
    ds_read_b128 a[44:47], v55
    s_waitcnt vmcnt(8)
    ds_write_b128 v48, a[48:51]
    ds_write_b128 v49, a[52:55]
    ds_write_b128 v50, a[56:59]
    ds_write_b128 v51, a[60:63]
    s_waitcnt lgkmcnt(8)
    ds_read_b128 a[48:51], v52
    ds_read_b128 a[52:55], v53
    ds_read_b128 a[56:59], v54
    ds_read_b128 a[60:63], v55
    s_waitcnt lgkmcnt(0)
    s_waitcnt vmcnt(4)
    ds_write_b128 v48, a[64:67]
    ds_write_b128 v49, a[68:71]
    ds_write_b128 v50, a[72:75]
    ds_write_b128 v51, a[76:79]
    ds_read_b128 a[64:67], v52
    ds_read_b128 a[68:71], v53
    ds_read_b128 a[72:75], v54
    ds_read_b128 a[76:79], v55
    s_waitcnt vmcnt(0)
    ds_write_b128 v48, a[80:83]
    ds_write_b128 v49, a[84:87]
    ds_write_b128 v50, a[88:91]
    ds_write_b128 v51, a[92:95]
    s_waitcnt lgkmcnt(8)
    ds_read_b128 a[80:83], v52
    ds_read_b128 a[84:87], v53
    ds_read_b128 a[88:91], v54
    ds_read_b128 a[92:95], v55
    v_mov_b32 v6, 0
    ds_read_b32 v7, v6 offset:9504
    s_waitcnt lgkmcnt(0)
    v_cmp_ne_u32 vcc, 1, v7
    s_nop 4
    s_cbranch_vccnz L_yq_late
    v_and_b32 v6, 3, v2
    v_lshlrev_b32 v6, 8, v6
    v_lshl_add_u32 v6, v3, 4, v6
    ds_read_b128 v[32:35], v6 offset:8192
    ds_read_b128 v[36:39], v6 offset:8256
    ds_read_b128 v[40:43], v6 offset:8320
    ds_read_b128 v[44:47], v6 offset:8384
    s_waitcnt lgkmcnt(0)
    v_mfma_f32_16x16x32_bf16 v[8:11], a[0:3], v[32:35], 0
    v_mfma_f32_16x16x32_bf16 v[8:11], a[4:7], v[36:39], v[8:11]
    v_mfma_f32_16x16x32_bf16 v[8:11], a[8:11], v[40:43], v[8:11]
    v_mfma_f32_16x16x32_bf16 v[8:11], a[12:15], v[44:47], v[8:11]
    v_mfma_f32_16x16x32_bf16 v[12:15], a[16:19], v[32:35], 0
    v_mfma_f32_16x16x32_bf16 v[12:15], a[20:23], v[36:39], v[12:15]
    v_mfma_f32_16x16x32_bf16 v[12:15], a[24:27], v[40:43], v[12:15]
    v_mfma_f32_16x16x32_bf16 v[12:15], a[28:31], v[44:47], v[12:15]
    v_mfma_f32_16x16x32_bf16 v[16:19], a[32:35], v[32:35], 0
    v_mfma_f32_16x16x32_bf16 v[16:19], a[36:39], v[36:39], v[16:19]
    v_mfma_f32_16x16x32_bf16 v[16:19], a[40:43], v[40:43], v[16:19]
    v_mfma_f32_16x16x32_bf16 v[16:19], a[44:47], v[44:47], v[16:19]
    v_mfma_f32_16x16x32_bf16 v[20:23], a[48:51], v[32:35], 0
    v_mfma_f32_16x16x32_bf16 v[20:23], a[52:55], v[36:39], v[20:23]
    v_mfma_f32_16x16x32_bf16 v[20:23], a[56:59], v[40:43], v[20:23]
    v_mfma_f32_16x16x32_bf16 v[20:23], a[60:63], v[44:47], v[20:23]
    v_mfma_f32_16x16x32_bf16 v[24:27], a[64:67], v[32:35], 0
    v_mfma_f32_16x16x32_bf16 v[24:27], a[68:71], v[36:39], v[24:27]
    v_mfma_f32_16x16x32_bf16 v[24:27], a[72:75], v[40:43], v[24:27]
    v_mfma_f32_16x16x32_bf16 v[24:27], a[76:79], v[44:47], v[24:27]
    v_mfma_f32_16x16x32_bf16 v[28:31], a[80:83], v[32:35], 0
    v_mfma_f32_16x16x32_bf16 v[28:31], a[84:87], v[36:39], v[28:31]
    v_mfma_f32_16x16x32_bf16 v[28:31], a[88:91], v[40:43], v[28:31]
    v_mfma_f32_16x16x32_bf16 v[28:31], a[92:95], v[44:47], v[28:31]
    s_nop 7
    s_lshl_b32 s20, s12, 4
    v_lshlrev_b32 v7, 2, v1
    v_add_u32 v7, s20, v7
    v_max3_f32 v44, v8, v9, v10
    v_max3_f32 v32, v11, v12, v13
    v_max3_f32 v44, v44, v14, v15
    v_max3_f32 v32, v32, v16, v17
    v_max3_f32 v44, v44, v18, v19
    v_max3_f32 v32, v32, v20, v21
    v_max3_f32 v44, v44, v22, v23
    v_max3_f32 v32, v32, v24, v25
    v_max3_f32 v44, v44, v26, v27
    v_max3_f32 v32, v32, v28, v29
    v_max3_f32 v44, v44, v30, v31
    v_max_f32 v44, v44, v32
    v_mov_b32 v32, v44
    s_nop 1
    v_permlane32_swap_b32 v44, v32
    v_max_f32 v44, v44, v32
    v_mov_b32 v32, v44
    s_nop 1
    v_permlane16_swap_b32 v44, v32
    v_max_f32 v44, v44, v32
    v_mul_f32 v32, s42, v44
    v_fma_f32 v8, v8, s42, -v32
    v_fma_f32 v9, v9, s42, -v32
    v_fma_f32 v10, v10, s42, -v32
    v_fma_f32 v11, v11, s42, -v32
    v_fma_f32 v12, v12, s42, -v32
    v_fma_f32 v13, v13, s42, -v32
    v_fma_f32 v14, v14, s42, -v32
    v_fma_f32 v15, v15, s42, -v32
    v_fma_f32 v16, v16, s42, -v32
    v_fma_f32 v17, v17, s42, -v32
    v_fma_f32 v18, v18, s42, -v32
    v_fma_f32 v19, v19, s42, -v32
    v_fma_f32 v20, v20, s42, -v32
    v_fma_f32 v21, v21, s42, -v32
    v_fma_f32 v22, v22, s42, -v32
    v_fma_f32 v23, v23, s42, -v32
    v_fma_f32 v24, v24, s42, -v32
    v_fma_f32 v25, v25, s42, -v32
    v_fma_f32 v26, v26, s42, -v32
    v_fma_f32 v27, v27, s42, -v32
    v_fma_f32 v28, v28, s42, -v32
    v_fma_f32 v29, v29, s42, -v32
    v_fma_f32 v30, v30, s42, -v32
    v_fma_f32 v31, v31, s42, -v32
    v_exp_f32 v8, v8
    v_exp_f32 v9, v9
    v_exp_f32 v10, v10
    v_exp_f32 v11, v11
    v_exp_f32 v12, v12
    v_exp_f32 v13, v13
    v_exp_f32 v14, v14
    v_exp_f32 v15, v15
    v_exp_f32 v16, v16
    v_exp_f32 v17, v17
    v_exp_f32 v18, v18
    v_exp_f32 v19, v19
    v_exp_f32 v20, v20
    v_exp_f32 v21, v21
    v_exp_f32 v22, v22
    v_exp_f32 v23, v23
    v_exp_f32 v24, v24
    v_exp_f32 v25, v25
    v_exp_f32 v26, v26
    v_exp_f32 v27, v27
    v_exp_f32 v28, v28
    v_exp_f32 v29, v29
    v_exp_f32 v30, v30
    v_exp_f32 v31, v31
    v_pk_add_f32 v[34:35], v[8:9], v[10:11]
    v_pk_add_f32 v[36:37], v[12:13], v[14:15]
    v_pk_add_f32 v[34:35], v[34:35], v[16:17]
    v_pk_add_f32 v[36:37], v[36:37], v[18:19]
    v_pk_add_f32 v[34:35], v[34:35], v[20:21]
    v_pk_add_f32 v[36:37], v[36:37], v[22:23]
    v_pk_add_f32 v[34:35], v[34:35], v[24:25]
    v_pk_add_f32 v[36:37], v[36:37], v[26:27]
    v_pk_add_f32 v[34:35], v[34:35], v[28:29]
    v_pk_add_f32 v[36:37], v[36:37], v[30:31]
    v_pk_add_f32 v[34:35], v[34:35], v[36:37]
    v_cvt_pk_bf16_f32 v8, v8, v9
    v_cvt_pk_bf16_f32 v9, v10, v11
    v_cvt_pk_bf16_f32 v10, v12, v13
    v_cvt_pk_bf16_f32 v11, v14, v15
    v_cvt_pk_bf16_f32 v12, v16, v17
    v_cvt_pk_bf16_f32 v13, v18, v19
    v_cvt_pk_bf16_f32 v14, v20, v21
    v_cvt_pk_bf16_f32 v15, v22, v23
    v_cvt_pk_bf16_f32 v16, v24, v25
    v_cvt_pk_bf16_f32 v17, v26, v27
    v_cvt_pk_bf16_f32 v18, v28, v29
    v_cvt_pk_bf16_f32 v19, v30, v31
    v_add_f32 v45, v34, v35
    v_mov_b32 v33, v45
    s_nop 1
    v_permlane32_swap_b32 v45, v33
    v_add_f32 v45, v45, v33
    v_mov_b32 v33, v45
    s_nop 1
    v_permlane16_swap_b32 v45, v33
    v_add_f32 v45, v45, v33
    s_mov_b64 exec, 0xf
    ds_write_b32 v7, v44 offset:9216
    ds_write_b32 v7, v45 offset:9344
    s_mov_b64 exec, -1
    s_lshl_b32 s20, s12, 2
    v_mov_b32 v6, s20
    v_mov_b32 v7, 1
    s_waitcnt lgkmcnt(0)
    ds_write_b32 v6, v7 offset:9536
    v_lshlrev_b32 v6, 4, v0
    v_add_u32 v6, 61952, v6
    ds_read_b128 v[20:23], v6
    ds_read_b128 v[24:27], v6 offset:8192
    ds_read_b64 v[28:29], v6 offset:16384
    s_add_u32 s20, s13, 0
    buffer_load_dwordx4 v[64:67], v5, s[28:31], s20 offen offset:0 nt
    buffer_load_dwordx4 v[68:71], v5, s[28:31], s20 offen offset:1024 nt
    buffer_load_dwordx4 v[72:75], v5, s[28:31], s20 offen offset:2048 nt
    buffer_load_dwordx4 v[76:79], v5, s[28:31], s20 offen offset:3072 nt
    s_add_u32 s20, s13, 4096
    buffer_load_dwordx4 v[80:83], v5, s[28:31], s20 offen offset:0 nt
    buffer_load_dwordx4 v[84:87], v5, s[28:31], s20 offen offset:1024 nt
    buffer_load_dwordx4 v[88:91], v5, s[28:31], s20 offen offset:2048 nt
    buffer_load_dwordx4 v[92:95], v5, s[28:31], s20 offen offset:3072 nt
    s_add_u32 s20, s13, 8192
    buffer_load_dwordx4 v[96:99], v5, s[28:31], s20 offen offset:0 nt
    buffer_load_dwordx4 v[100:103], v5, s[28:31], s20 offen offset:1024 nt
    buffer_load_dwordx4 v[104:107], v5, s[28:31], s20 offen offset:2048 nt
    buffer_load_dwordx4 v[108:111], v5, s[28:31], s20 offen offset:3072 nt
    s_add_u32 s20, s13, 12288
    buffer_load_dwordx4 v[112:115], v5, s[28:31], s20 offen offset:0 nt
    buffer_load_dwordx4 v[116:119], v5, s[28:31], s20 offen offset:1024 nt
    buffer_load_dwordx4 v[120:123], v5, s[28:31], s20 offen offset:2048 nt
    buffer_load_dwordx4 v[124:127], v5, s[28:31], s20 offen offset:3072 nt
    s_add_u32 s20, s13, 16384
    buffer_load_dwordx4 v[128:131], v5, s[28:31], s20 offen offset:0 nt
    buffer_load_dwordx4 v[132:135], v5, s[28:31], s20 offen offset:1024 nt
    buffer_load_dwordx4 v[136:139], v5, s[28:31], s20 offen offset:2048 nt
    buffer_load_dwordx4 v[140:143], v5, s[28:31], s20 offen offset:3072 nt
    s_add_u32 s20, s13, 20480
    buffer_load_dwordx4 v[144:147], v5, s[28:31], s20 offen offset:0 nt
    buffer_load_dwordx4 v[148:151], v5, s[28:31], s20 offen offset:1024 nt
    buffer_load_dwordx4 v[152:155], v5, s[28:31], s20 offen offset:2048 nt
    buffer_load_dwordx4 v[156:159], v5, s[28:31], s20 offen offset:3072 nt
    s_setprio 0
    v_lshlrev_b32 v6, 12, v3
    v_lshl_add_u32 v6, v2, 4, v6
    buffer_load_dwordx4 v[48:51], v6, s[48:51], s7 offen offset:0 nt
    buffer_load_dwordx4 v[52:55], v6, s[48:51], s7 offen offset:1024 nt
    buffer_load_dwordx4 v[56:59], v6, s[48:51], s7 offen offset:2048 nt
    buffer_load_dwordx4 v[60:63], v6, s[48:51], s7 offen offset:3072 nt
    s_branch L_yq_pv
L_yq_late:
    s_add_u32 s20, s13, 0
    buffer_load_dwordx4 v[64:67], v5, s[28:31], s20 offen offset:0 nt
    buffer_load_dwordx4 v[68:71], v5, s[28:31], s20 offen offset:1024 nt
    buffer_load_dwordx4 v[72:75], v5, s[28:31], s20 offen offset:2048 nt
    buffer_load_dwordx4 v[76:79], v5, s[28:31], s20 offen offset:3072 nt
    s_add_u32 s20, s13, 4096
    buffer_load_dwordx4 v[80:83], v5, s[28:31], s20 offen offset:0 nt
    buffer_load_dwordx4 v[84:87], v5, s[28:31], s20 offen offset:1024 nt
    buffer_load_dwordx4 v[88:91], v5, s[28:31], s20 offen offset:2048 nt
    buffer_load_dwordx4 v[92:95], v5, s[28:31], s20 offen offset:3072 nt
    s_add_u32 s20, s13, 8192
    buffer_load_dwordx4 v[96:99], v5, s[28:31], s20 offen offset:0 nt
    buffer_load_dwordx4 v[100:103], v5, s[28:31], s20 offen offset:1024 nt
    buffer_load_dwordx4 v[104:107], v5, s[28:31], s20 offen offset:2048 nt
    buffer_load_dwordx4 v[108:111], v5, s[28:31], s20 offen offset:3072 nt
    s_add_u32 s20, s13, 12288
    buffer_load_dwordx4 v[112:115], v5, s[28:31], s20 offen offset:0 nt
    buffer_load_dwordx4 v[116:119], v5, s[28:31], s20 offen offset:1024 nt
    buffer_load_dwordx4 v[120:123], v5, s[28:31], s20 offen offset:2048 nt
    buffer_load_dwordx4 v[124:127], v5, s[28:31], s20 offen offset:3072 nt
    s_add_u32 s20, s13, 16384
    buffer_load_dwordx4 v[128:131], v5, s[28:31], s20 offen offset:0 nt
    buffer_load_dwordx4 v[132:135], v5, s[28:31], s20 offen offset:1024 nt
    buffer_load_dwordx4 v[136:139], v5, s[28:31], s20 offen offset:2048 nt
    buffer_load_dwordx4 v[140:143], v5, s[28:31], s20 offen offset:3072 nt
    s_add_u32 s20, s13, 20480
    buffer_load_dwordx4 v[144:147], v5, s[28:31], s20 offen offset:0 nt
    buffer_load_dwordx4 v[148:151], v5, s[28:31], s20 offen offset:1024 nt
    buffer_load_dwordx4 v[152:155], v5, s[28:31], s20 offen offset:2048 nt
    buffer_load_dwordx4 v[156:159], v5, s[28:31], s20 offen offset:3072 nt
    s_setprio 0
    v_lshlrev_b32 v6, 12, v3
    v_lshl_add_u32 v6, v2, 4, v6
    buffer_load_dwordx4 v[48:51], v6, s[48:51], s7 offen offset:0 nt
    buffer_load_dwordx4 v[52:55], v6, s[48:51], s7 offen offset:1024 nt
    buffer_load_dwordx4 v[56:59], v6, s[48:51], s7 offen offset:2048 nt
    buffer_load_dwordx4 v[60:63], v6, s[48:51], s7 offen offset:3072 nt
    s_mov_b32 s65, 5000750
    v_mov_b32 v6, 0
L_wq2:
    ds_read_b32 v7, v6 offset:9504
    s_waitcnt lgkmcnt(0)
    v_cmp_ne_u32 vcc, 1, v7
    s_nop 4
    s_cbranch_vccz L_wqok2
    s_sub_u32 s65, s65, 1
    s_cmp_lg_u32 s65, 0
    s_cbranch_scc1 L_wq2
    s_branch L_end
L_wqok2:
    v_and_b32 v6, 3, v2
    v_lshlrev_b32 v6, 8, v6
    v_lshl_add_u32 v6, v3, 4, v6
    ds_read_b128 v[32:35], v6 offset:8192
    ds_read_b128 v[36:39], v6 offset:8256
    ds_read_b128 v[40:43], v6 offset:8320
    ds_read_b128 v[44:47], v6 offset:8384
    s_waitcnt lgkmcnt(0)
    v_mfma_f32_16x16x32_bf16 v[8:11], a[0:3], v[32:35], 0
    v_mfma_f32_16x16x32_bf16 v[8:11], a[4:7], v[36:39], v[8:11]
    v_mfma_f32_16x16x32_bf16 v[8:11], a[8:11], v[40:43], v[8:11]
    v_mfma_f32_16x16x32_bf16 v[8:11], a[12:15], v[44:47], v[8:11]
    v_mfma_f32_16x16x32_bf16 v[12:15], a[16:19], v[32:35], 0
    v_mfma_f32_16x16x32_bf16 v[12:15], a[20:23], v[36:39], v[12:15]
    v_mfma_f32_16x16x32_bf16 v[12:15], a[24:27], v[40:43], v[12:15]
    v_mfma_f32_16x16x32_bf16 v[12:15], a[28:31], v[44:47], v[12:15]
    v_mfma_f32_16x16x32_bf16 v[16:19], a[32:35], v[32:35], 0
    v_mfma_f32_16x16x32_bf16 v[16:19], a[36:39], v[36:39], v[16:19]
    v_mfma_f32_16x16x32_bf16 v[16:19], a[40:43], v[40:43], v[16:19]
    v_mfma_f32_16x16x32_bf16 v[16:19], a[44:47], v[44:47], v[16:19]
    v_mfma_f32_16x16x32_bf16 v[20:23], a[48:51], v[32:35], 0
    v_mfma_f32_16x16x32_bf16 v[20:23], a[52:55], v[36:39], v[20:23]
    v_mfma_f32_16x16x32_bf16 v[20:23], a[56:59], v[40:43], v[20:23]
    v_mfma_f32_16x16x32_bf16 v[20:23], a[60:63], v[44:47], v[20:23]
    v_mfma_f32_16x16x32_bf16 v[24:27], a[64:67], v[32:35], 0
    v_mfma_f32_16x16x32_bf16 v[24:27], a[68:71], v[36:39], v[24:27]
    v_mfma_f32_16x16x32_bf16 v[24:27], a[72:75], v[40:43], v[24:27]
    v_mfma_f32_16x16x32_bf16 v[24:27], a[76:79], v[44:47], v[24:27]
    v_mfma_f32_16x16x32_bf16 v[28:31], a[80:83], v[32:35], 0
    v_mfma_f32_16x16x32_bf16 v[28:31], a[84:87], v[36:39], v[28:31]
    v_mfma_f32_16x16x32_bf16 v[28:31], a[88:91], v[40:43], v[28:31]
    v_mfma_f32_16x16x32_bf16 v[28:31], a[92:95], v[44:47], v[28:31]
    s_nop 7
    s_lshl_b32 s20, s12, 4
    v_lshlrev_b32 v7, 2, v1
    v_add_u32 v7, s20, v7
    v_max3_f32 v44, v8, v9, v10
    v_max3_f32 v32, v11, v12, v13
    v_max3_f32 v44, v44, v14, v15
    v_max3_f32 v32, v32, v16, v17
    v_max3_f32 v44, v44, v18, v19
    v_max3_f32 v32, v32, v20, v21
    v_max3_f32 v44, v44, v22, v23
    v_max3_f32 v32, v32, v24, v25
    v_max3_f32 v44, v44, v26, v27
    v_max3_f32 v32, v32, v28, v29
    v_max3_f32 v44, v44, v30, v31
    v_max_f32 v44, v44, v32
    v_mov_b32 v32, v44
    s_nop 1
    v_permlane32_swap_b32 v44, v32
    v_max_f32 v44, v44, v32
    v_mov_b32 v32, v44
    s_nop 1
    v_permlane16_swap_b32 v44, v32
    v_max_f32 v44, v44, v32
    v_mul_f32 v32, s42, v44
    v_fma_f32 v8, v8, s42, -v32
    v_fma_f32 v9, v9, s42, -v32
    v_fma_f32 v10, v10, s42, -v32
    v_fma_f32 v11, v11, s42, -v32
    v_fma_f32 v12, v12, s42, -v32
    v_fma_f32 v13, v13, s42, -v32
    v_fma_f32 v14, v14, s42, -v32
    v_fma_f32 v15, v15, s42, -v32
    v_fma_f32 v16, v16, s42, -v32
    v_fma_f32 v17, v17, s42, -v32
    v_fma_f32 v18, v18, s42, -v32
    v_fma_f32 v19, v19, s42, -v32
    v_fma_f32 v20, v20, s42, -v32
    v_fma_f32 v21, v21, s42, -v32
    v_fma_f32 v22, v22, s42, -v32
    v_fma_f32 v23, v23, s42, -v32
    v_fma_f32 v24, v24, s42, -v32
    v_fma_f32 v25, v25, s42, -v32
    v_fma_f32 v26, v26, s42, -v32
    v_fma_f32 v27, v27, s42, -v32
    v_fma_f32 v28, v28, s42, -v32
    v_fma_f32 v29, v29, s42, -v32
    v_fma_f32 v30, v30, s42, -v32
    v_fma_f32 v31, v31, s42, -v32
    v_exp_f32 v8, v8
    v_exp_f32 v9, v9
    v_exp_f32 v10, v10
    v_exp_f32 v11, v11
    v_exp_f32 v12, v12
    v_exp_f32 v13, v13
    v_exp_f32 v14, v14
    v_exp_f32 v15, v15
    v_exp_f32 v16, v16
    v_exp_f32 v17, v17
    v_exp_f32 v18, v18
    v_exp_f32 v19, v19
    v_exp_f32 v20, v20
    v_exp_f32 v21, v21
    v_exp_f32 v22, v22
    v_exp_f32 v23, v23
    v_exp_f32 v24, v24
    v_exp_f32 v25, v25
    v_exp_f32 v26, v26
    v_exp_f32 v27, v27
    v_exp_f32 v28, v28
    v_exp_f32 v29, v29
    v_exp_f32 v30, v30
    v_exp_f32 v31, v31
    v_pk_add_f32 v[34:35], v[8:9], v[10:11]
    v_pk_add_f32 v[36:37], v[12:13], v[14:15]
    v_pk_add_f32 v[34:35], v[34:35], v[16:17]
    v_pk_add_f32 v[36:37], v[36:37], v[18:19]
    v_pk_add_f32 v[34:35], v[34:35], v[20:21]
    v_pk_add_f32 v[36:37], v[36:37], v[22:23]
    v_pk_add_f32 v[34:35], v[34:35], v[24:25]
    v_pk_add_f32 v[36:37], v[36:37], v[26:27]
    v_pk_add_f32 v[34:35], v[34:35], v[28:29]
    v_pk_add_f32 v[36:37], v[36:37], v[30:31]
    v_pk_add_f32 v[34:35], v[34:35], v[36:37]
    v_cvt_pk_bf16_f32 v8, v8, v9
    v_cvt_pk_bf16_f32 v9, v10, v11
    v_cvt_pk_bf16_f32 v10, v12, v13
    v_cvt_pk_bf16_f32 v11, v14, v15
    v_cvt_pk_bf16_f32 v12, v16, v17
    v_cvt_pk_bf16_f32 v13, v18, v19
    v_cvt_pk_bf16_f32 v14, v20, v21
    v_cvt_pk_bf16_f32 v15, v22, v23
    v_cvt_pk_bf16_f32 v16, v24, v25
    v_cvt_pk_bf16_f32 v17, v26, v27
    v_cvt_pk_bf16_f32 v18, v28, v29
    v_cvt_pk_bf16_f32 v19, v30, v31
    v_add_f32 v45, v34, v35
    v_mov_b32 v33, v45
    s_nop 1
    v_permlane32_swap_b32 v45, v33
    v_add_f32 v45, v45, v33
    v_mov_b32 v33, v45
    s_nop 1
    v_permlane16_swap_b32 v45, v33
    v_add_f32 v45, v45, v33
    s_mov_b64 exec, 0xf
    ds_write_b32 v7, v44 offset:9216
    ds_write_b32 v7, v45 offset:9344
    s_mov_b64 exec, -1
    s_lshl_b32 s20, s12, 2
    v_mov_b32 v6, s20
    v_mov_b32 v7, 1
    s_waitcnt lgkmcnt(0)
    ds_write_b32 v6, v7 offset:9536
    v_lshlrev_b32 v6, 4, v0
    v_add_u32 v6, 61952, v6
    ds_read_b128 v[20:23], v6
    ds_read_b128 v[24:27], v6 offset:8192
    ds_read_b64 v[28:29], v6 offset:16384
L_yq_pv:
    s_waitcnt vmcnt(20)
    v_perm_b32 v32, v68, v64, s40
    v_perm_b32 v33, v76, v72, s40
    v_perm_b32 v34, v84, v80, s40
    v_perm_b32 v35, v92, v88, s40
    v_perm_b32 v36, v68, v64, s41
    v_perm_b32 v37, v76, v72, s41
    v_perm_b32 v38, v84, v80, s41
    v_perm_b32 v39, v92, v88, s41
    v_mfma_f32_16x16x32_bf16 a[0:3], v[8:11], v[32:35], 0
    v_perm_b32 v40, v69, v65, s40
    v_perm_b32 v41, v77, v73, s40
    v_perm_b32 v42, v85, v81, s40
    v_perm_b32 v43, v93, v89, s40
    v_mfma_f32_16x16x32_bf16 a[4:7], v[8:11], v[36:39], 0
    v_perm_b32 v44, v69, v65, s41
    v_perm_b32 v45, v77, v73, s41
    v_perm_b32 v46, v85, v81, s41
    v_perm_b32 v47, v93, v89, s41
    v_mfma_f32_16x16x32_bf16 a[8:11], v[8:11], v[40:43], 0
    v_perm_b32 v32, v70, v66, s40
    v_perm_b32 v33, v78, v74, s40
    v_perm_b32 v34, v86, v82, s40
    v_perm_b32 v35, v94, v90, s40
    v_mfma_f32_16x16x32_bf16 a[12:15], v[8:11], v[44:47], 0
    v_perm_b32 v36, v70, v66, s41
    v_perm_b32 v37, v78, v74, s41
    v_perm_b32 v38, v86, v82, s41
    v_perm_b32 v39, v94, v90, s41
    v_mfma_f32_16x16x32_bf16 a[16:19], v[8:11], v[32:35], 0
    v_perm_b32 v40, v71, v67, s40
    v_perm_b32 v41, v79, v75, s40
    v_perm_b32 v42, v87, v83, s40
    v_perm_b32 v43, v95, v91, s40
    v_mfma_f32_16x16x32_bf16 a[20:23], v[8:11], v[36:39], 0
    v_perm_b32 v44, v71, v67, s41
    v_perm_b32 v45, v79, v75, s41
    v_perm_b32 v46, v87, v83, s41
    v_perm_b32 v47, v95, v91, s41
    v_mfma_f32_16x16x32_bf16 a[24:27], v[8:11], v[40:43], 0
    s_nop 1
    v_mfma_f32_16x16x32_bf16 a[28:31], v[8:11], v[44:47], 0
    s_waitcnt vmcnt(12)
    v_perm_b32 v32, v100, v96, s40
    v_perm_b32 v33, v108, v104, s40
    v_perm_b32 v34, v116, v112, s40
    v_perm_b32 v35, v124, v120, s40
    v_perm_b32 v36, v100, v96, s41
    v_perm_b32 v37, v108, v104, s41
    v_perm_b32 v38, v116, v112, s41
    v_perm_b32 v39, v124, v120, s41
    v_mfma_f32_16x16x32_bf16 a[0:3], v[12:15], v[32:35], a[0:3]
    v_perm_b32 v40, v101, v97, s40
    v_perm_b32 v41, v109, v105, s40
    v_perm_b32 v42, v117, v113, s40
    v_perm_b32 v43, v125, v121, s40
    v_mfma_f32_16x16x32_bf16 a[4:7], v[12:15], v[36:39], a[4:7]
    v_perm_b32 v44, v101, v97, s41
    v_perm_b32 v45, v109, v105, s41
    v_perm_b32 v46, v117, v113, s41
    v_perm_b32 v47, v125, v121, s41
    v_mfma_f32_16x16x32_bf16 a[8:11], v[12:15], v[40:43], a[8:11]
    v_perm_b32 v32, v102, v98, s40
    v_perm_b32 v33, v110, v106, s40
    v_perm_b32 v34, v118, v114, s40
    v_perm_b32 v35, v126, v122, s40
    v_mfma_f32_16x16x32_bf16 a[12:15], v[12:15], v[44:47], a[12:15]
    v_perm_b32 v36, v102, v98, s41
    v_perm_b32 v37, v110, v106, s41
    v_perm_b32 v38, v118, v114, s41
    v_perm_b32 v39, v126, v122, s41
    v_mfma_f32_16x16x32_bf16 a[16:19], v[12:15], v[32:35], a[16:19]
    v_perm_b32 v40, v103, v99, s40
    v_perm_b32 v41, v111, v107, s40
    v_perm_b32 v42, v119, v115, s40
    v_perm_b32 v43, v127, v123, s40
    v_mfma_f32_16x16x32_bf16 a[20:23], v[12:15], v[36:39], a[20:23]
    v_perm_b32 v44, v103, v99, s41
    v_perm_b32 v45, v111, v107, s41
    v_perm_b32 v46, v119, v115, s41
    v_perm_b32 v47, v127, v123, s41
    v_mfma_f32_16x16x32_bf16 a[24:27], v[12:15], v[40:43], a[24:27]
    s_nop 1
    v_mfma_f32_16x16x32_bf16 a[28:31], v[12:15], v[44:47], a[28:31]
L_young:
    s_waitcnt vmcnt(4)
    v_perm_b32 v32, v132, v128, s40
    v_perm_b32 v33, v140, v136, s40
    v_perm_b32 v34, v148, v144, s40
    v_perm_b32 v35, v156, v152, s40
    v_perm_b32 v36, v132, v128, s41
    v_perm_b32 v37, v140, v136, s41
    v_perm_b32 v38, v148, v144, s41
    v_perm_b32 v39, v156, v152, s41
    v_mfma_f32_16x16x32_bf16 a[0:3], v[16:19], v[32:35], a[0:3]
    v_perm_b32 v40, v133, v129, s40
    v_perm_b32 v41, v141, v137, s40
    v_perm_b32 v42, v149, v145, s40
    v_perm_b32 v43, v157, v153, s40
    v_mfma_f32_16x16x32_bf16 a[4:7], v[16:19], v[36:39], a[4:7]
    v_perm_b32 v44, v133, v129, s41
    v_perm_b32 v45, v141, v137, s41
    v_perm_b32 v46, v149, v145, s41
    v_perm_b32 v47, v157, v153, s41
    v_mfma_f32_16x16x32_bf16 a[8:11], v[16:19], v[40:43], a[8:11]
    v_perm_b32 v32, v134, v130, s40
    v_perm_b32 v33, v142, v138, s40
    v_perm_b32 v34, v150, v146, s40
    v_perm_b32 v35, v158, v154, s40
    v_mfma_f32_16x16x32_bf16 a[12:15], v[16:19], v[44:47], a[12:15]
    v_perm_b32 v36, v134, v130, s41
    v_perm_b32 v37, v142, v138, s41
    v_perm_b32 v38, v150, v146, s41
    v_perm_b32 v39, v158, v154, s41
    v_mfma_f32_16x16x32_bf16 a[16:19], v[16:19], v[32:35], a[16:19]
    v_perm_b32 v40, v135, v131, s40
    v_perm_b32 v41, v143, v139, s40
    v_perm_b32 v42, v151, v147, s40
    v_perm_b32 v43, v159, v155, s40
    v_mfma_f32_16x16x32_bf16 a[20:23], v[16:19], v[36:39], a[20:23]
    v_perm_b32 v44, v135, v131, s41
    v_perm_b32 v45, v143, v139, s41
    v_perm_b32 v46, v151, v147, s41
    v_perm_b32 v47, v159, v155, s41
    v_mfma_f32_16x16x32_bf16 a[24:27], v[16:19], v[40:43], a[24:27]
    s_nop 1
    v_mfma_f32_16x16x32_bf16 a[28:31], v[16:19], v[44:47], a[28:31]
    s_nop 5
    s_waitcnt lgkmcnt(0)
    s_mov_b64 exec, 0xffff
    ds_write_b128 v28, a[0:3] offset:10240
    ds_write_b128 v28, a[4:7] offset:10256
    ds_write_b128 v28, a[8:11] offset:10272
    ds_write_b128 v28, a[12:15] offset:10288
    ds_write_b128 v28, a[16:19] offset:10304
    ds_write_b128 v28, a[20:23] offset:10320
    ds_write_b128 v28, a[24:27] offset:10336
    s_nop 1
    ds_write_b128 v28, a[28:31] offset:10352
    s_mov_b64 exec, -1
    s_waitcnt lgkmcnt(0)
    s_branch L_D
L_light:
    s_mov_b32 s50, 4194304
    s_mov_b32 s51, 0x20000
    s_mov_b32 s58, 4096
    s_mov_b32 s59, 0x20000
    s_mov_b32 s40, 0x5040100
    s_mov_b32 s41, 0x7060302
    s_mov_b32 s42, 0x3e0293ee
    s_lshr_b32 s61, s2, 5
    s_and_b32 s61, s61, 3
    s_lshl_b32 s4, s8, 2
    s_add_u32 s61, s61, s4
    s_bfe_u32 s62, s2, 0x20003
    s_mul_i32 s11, s8, 30
    s_add_u32 s11, s11, s43
    s_lshl_b32 s67, s11, 11
    s_add_u32 s67, s67, 139264
    s_lshl_b32 s20, s61, 7
    s_lshl_b32 s21, s12, 4
    s_add_u32 s20, s20, s21
    s_lshl_b32 s20, s20, 10
    s_lshl_b32 s21, s62, 8
    s_add_u32 s7, s20, s21
    s_lshl_b32 s21, s60, 2
    s_add_u32 s21, s21, s62
    s_lshl_b32 s21, s21, 5
    s_add_u32 s21, s21, s61
    s_lshl_b32 s21, s21, 11
    s_lshl_b32 s20, s12, 7
    s_add_u32 s21, s21, s20
    s_add_u32 s6, s21, 630784
    s_and_b32 s21, s61, 3
    s_lshl_b32 s44, s21, 9
    s_lshl_b32 s20, s12, 6
    s_add_u32 s44, s44, s20
    s_add_u32 s44, s44, 1318912
    v_lshrrev_b32 v8, 5, v0
    v_mul_u32_u24 v8, 144, v8
    v_and_b32 v9, 31, v0
    v_lshl_add_u32 v8, v9, 2, v8
    v_and_b32 v9, 3, v1
    v_lshlrev_b32 v9, 9, v9
    v_lshl_add_u32 v9, v3, 4, v9
    s_lshl_b32 s20, s12, 6
    v_add_u32 v9, s20, v9
    s_mul_i32 s20, s12, 4112
    v_add_u32 v10, s20, v5
    s_mul_i32 s20, s12, 2304
    v_mul_u32_u24 v16, 144, v2
    v_add_u32 v16, s20, v16
    v_lshrrev_b32 v15, 1, v2
    v_mul_u32_u24 v15, 4112, v15
    v_and_b32 v18, 1, v2
    v_lshl_add_u32 v15, v18, 7, v15
    v_lshl_add_u32 v15, v3, 8, v15
    s_lshr_b32 s20, s12, 1
    s_lshl_b32 s21, s20, 10
    s_and_b32 s22, s12, 1
    s_lshl_b32 s22, s22, 3
    s_add_u32 s21, s21, s22
    v_add_u32 v15, s21, v15
    v_bfe_u32 v18, v2, 2, 1
    v_lshlrev_b32 v14, 8, v18
    v_lshl_add_u32 v14, v3, 4, v14
    s_lshl_b32 s20, s20, 6
    s_add_u32 s20, s20, s22
    v_add_u32 v11, s20, v14
    v_and_b32 v19, 3, v2
    v_lshrrev_b32 v24, 3, v2
    v_lshl_add_u32 v19, v24, 2, v19
    s_cmp_eq_u32 s60, 0
    s_cselect_b32 s22, 3, 12
    s_cselect_b32 s23, 0, 6
    s_mul_i32 s21, s8, 30
    s_add_u32 s23, s23, s21
    v_mul_lo_u32 v18, v18, s22
    v_add_u32 v18, s23, v18
    v_add_u32 v18, v18, v19
    v_cmp_gt_u32 s[46:47], s22, v19
    v_add_u32 v19, 8, v19
    v_cmp_gt_u32 s[14:15], s22, v19
    v_lshlrev_b32 v12, 11, v18
    v_lshl_add_u32 v12, v3, 4, v12
    v_mov_b32 v19, 0x80000000
    v_add_u32 v13, 0x4000, v12
    v_cndmask_b32 v12, v19, v12, s[46:47]
    v_cndmask_b32 v13, v19, v13, s[14:15]
    v_lshlrev_b32 v17, 10, v3
    v_lshrrev_b32 v19, 1, v2
    v_lshl_add_u32 v17, v19, 4, v17
    v_lshlrev_b32 v19, 4, v0
    v_add_u32 v19, 61952, v19
    ds_write_b128 v19, v[8:11]
    ds_write_b128 v19, v[12:15] offset:8192
    ds_write_b64 v19, v[16:17] offset:16384
    s_waitcnt vmcnt(0)
    v_perm_b32 v34, v52, v48, s40
    v_perm_b32 v35, v60, v56, s40
    v_perm_b32 v36, v52, v48, s41
    v_perm_b32 v37, v60, v56, s41
    v_mfma_f32_16x16x16_bf16 v[64:67], v[34:35], v[32:33], 0
    v_perm_b32 v38, v53, v49, s40
    v_perm_b32 v39, v61, v57, s40
    v_mfma_f32_16x16x16_bf16 v[68:71], v[36:37], v[32:33], 0
    v_perm_b32 v40, v53, v49, s41
    v_perm_b32 v41, v61, v57, s41
    v_mfma_f32_16x16x16_bf16 v[72:75], v[38:39], v[32:33], 0
    v_perm_b32 v34, v54, v50, s40
    v_perm_b32 v35, v62, v58, s40
    v_mfma_f32_16x16x16_bf16 v[76:79], v[40:41], v[32:33], 0
    v_perm_b32 v36, v54, v50, s41
    v_perm_b32 v37, v62, v58, s41
    v_mfma_f32_16x16x16_bf16 v[80:83], v[34:35], v[32:33], 0
    v_perm_b32 v38, v55, v51, s40
    v_perm_b32 v39, v63, v59, s40
    v_mfma_f32_16x16x16_bf16 v[84:87], v[36:37], v[32:33], 0
    v_perm_b32 v40, v55, v51, s41
    v_perm_b32 v41, v63, v59, s41
    v_mfma_f32_16x16x16_bf16 v[88:91], v[38:39], v[32:33], 0
    v_and_b32 v8, 1, v2
    v_lshlrev_b32 v8, 9, v8
    v_mfma_f32_16x16x16_bf16 v[92:95], v[40:41], v[32:33], 0
    v_bfe_u32 v9, v2, 1, 1
    v_lshl_add_u32 v8, v9, 8, v8
    v_and_b32 v9, 1, v3
    v_lshl_add_u32 v8, v9, 7, v8
    s_lshl_b32 s20, s12, 10
    v_add_u32 v8, s20, v8
    s_mov_b32 s20, 0x00050005
    s_mov_b32 s21, 0x000a000a
    s_waitcnt lgkmcnt(0)
    s_mov_b64 exec, s[20:21]
    ds_write2_b32 v8, v64, v65 offset0:0 offset1:8
    ds_write2_b32 v8, v66, v67 offset0:16 offset1:24
    ds_write2_b32 v8, v68, v69 offset0:1 offset1:9
    ds_write2_b32 v8, v70, v71 offset0:17 offset1:25
    ds_write2_b32 v8, v72, v73 offset0:2 offset1:10
    ds_write2_b32 v8, v74, v75 offset0:18 offset1:26
    ds_write2_b32 v8, v76, v77 offset0:3 offset1:11
    ds_write2_b32 v8, v78, v79 offset0:19 offset1:27
    s_waitcnt lgkmcnt(4)
    ds_write2_b32 v8, v80, v81 offset0:4 offset1:12
    ds_write2_b32 v8, v82, v83 offset0:20 offset1:28
    ds_write2_b32 v8, v84, v85 offset0:5 offset1:13
    ds_write2_b32 v8, v86, v87 offset0:21 offset1:29
    ds_write2_b32 v8, v88, v89 offset0:6 offset1:14
    ds_write2_b32 v8, v90, v91 offset0:22 offset1:30
    ds_write2_b32 v8, v92, v93 offset0:7 offset1:15
    ds_write2_b32 v8, v94, v95 offset0:23 offset1:31
    s_mov_b64 exec, -1
    s_waitcnt lgkmcnt(0)
    s_cmp_eq_u32 s60, 0
    s_cselect_b32 s16, s68, s69
    s_cmp_eq_u32 s64, 0
    s_cselect_b32 s18, s68, s69
    s_add_u32 s16, s16, 1
    s_add_u32 s18, s18, 1
    s_xor_b32 s17, s16, 0x5bd1e995
    s_xor_b32 s19, s18, 0x5bd1e995
    s_lshl_b32 s45, s17, 24
    s_lshl_b32 s20, s12, 2
    v_mov_b32 v8, s20
    v_mov_b32 v9, 1
    s_mov_b64 exec, 1
    ds_write_b32 v8, v9 offset:9472
    s_mov_b64 exec, -1
    s_cmp_lg_u32 s12, 7
    s_cbranch_scc1 L_spare_rest
    s_mov_b32 s65, 100015
    v_and_b32 v6, 7, v1
    v_lshlrev_b32 v6, 2, v6
L_fw:
    ds_read_b32 v8, v6 offset:9472
    s_waitcnt lgkmcnt(0)
    v_cmp_ne_u32 vcc, 1, v8
    s_nop 4
    s_cbranch_vccz L_fok
    s_sub_u32 s65, s65, 1
    s_cmp_lg_u32 s65, 0
    s_cbranch_scc1 L_fw
    s_branch L_end
L_fok:
    v_lshlrev_b32 v6, 3, v1
    ds_read_b64 v[64:65], v6 offset:0
    ds_read_b64 v[66:67], v6 offset:512
    ds_read_b64 v[68:69], v6 offset:1024
    ds_read_b64 v[70:71], v6 offset:1536
    ds_read_b64 v[72:73], v6 offset:2048
    ds_read_b64 v[74:75], v6 offset:2560
    ds_read_b64 v[76:77], v6 offset:3072
    ds_read_b64 v[78:79], v6 offset:3584
    s_waitcnt lgkmcnt(4)
    ds_read_b64 v[80:81], v6 offset:4096
    ds_read_b64 v[82:83], v6 offset:4608
    ds_read_b64 v[84:85], v6 offset:5120
    ds_read_b64 v[86:87], v6 offset:5632
    ds_read_b64 v[88:89], v6 offset:6144
    ds_read_b64 v[90:91], v6 offset:6656
    ds_read_b64 v[92:93], v6 offset:7168
    ds_read_b64 v[94:95], v6 offset:7680
    v_mov_b32 v117, s16
    v_mov_b32 v119, s17
    s_lshl_b32 s20, s60, 3
    s_add_u32 s20, s20, s8
    s_lshl_b32 s20, s20, 4
    s_bfe_u32 s21, s2, 0x40003
    s_add_u32 s20, s20, s21
    s_lshl_b32 s20, s20, 9
    s_add_u32 s4, s20, 8192
    s_add_u32 s20, s4, 1179648
    s_waitcnt lgkmcnt(8)
    v_add_f32 v64, v64, v66
    v_add_f32 v65, v65, v67
    v_add_f32 v68, v68, v70
    v_add_f32 v69, v69, v71
    v_add_f32 v72, v72, v74
    v_add_f32 v73, v73, v75
    v_add_f32 v76, v76, v78
    v_add_f32 v77, v77, v79
    s_waitcnt lgkmcnt(0)
    v_add_f32 v80, v80, v82
    v_add_f32 v81, v81, v83
    v_add_f32 v84, v84, v86
    v_add_f32 v85, v85, v87
    v_add_f32 v88, v88, v90
    v_add_f32 v89, v89, v91
    v_add_f32 v92, v92, v94
    v_add_f32 v93, v93, v95
    v_add_f32 v64, v64, v68
    v_add_f32 v65, v65, v69
    v_add_f32 v72, v72, v76
    v_add_f32 v73, v73, v77
    v_add_f32 v80, v80, v84
    v_add_f32 v81, v81, v85
    v_add_f32 v88, v88, v92
    v_add_f32 v89, v89, v93
    v_add_f32 v64, v64, v72
    v_add_f32 v65, v65, v73
    v_add_f32 v80, v80, v88
    v_add_f32 v81, v81, v89
    v_add_f32 v64, v64, v80
    v_add_f32 v65, v65, v81
    v_cvt_pk_bf16_f32 v116, v64, v65
    v_mov_b32 v120, v6
    s_nop 0
    v_mov_b32_dpp v118, v116 quad_perm:[1,0,3,2] row_mask:0xf bank_mask:0xf
    s_mov_b32 exec_lo, 0x55555555
    s_mov_b32 exec_hi, 0x55555555
    buffer_store_dwordx4 v[116:119], v120, s[32:35], s20 offen
    s_mov_b64 exec, -1
    s_cmp_lg_u32 s9, 0
    s_cbranch_scc1 L_spare_h
    s_cmp_lg_u32 s66, 0
    s_cbranch_scc1 L_h_nok
    s_add_u32 s20, s13, 0
    buffer_load_dwordx4 a[0:3], v5, s[24:27], s20 offen offset:0 nt
    buffer_load_dwordx4 a[4:7], v5, s[24:27], s20 offen offset:1024 nt
    buffer_load_dwordx4 a[8:11], v5, s[24:27], s20 offen offset:2048 nt
    buffer_load_dwordx4 a[12:15], v5, s[24:27], s20 offen offset:3072 nt
    s_add_u32 s20, s13, 4096
    buffer_load_dwordx4 a[16:19], v5, s[24:27], s20 offen offset:0 nt
    buffer_load_dwordx4 a[20:23], v5, s[24:27], s20 offen offset:1024 nt
    buffer_load_dwordx4 a[24:27], v5, s[24:27], s20 offen offset:2048 nt
    buffer_load_dwordx4 a[28:31], v5, s[24:27], s20 offen offset:3072 nt
L_h_nok:
    s_lshl_b32 s21, s64, 3
    s_add_u32 s20, s8, s21
    s_lshl_b32 s23, s20, 13
    s_lshr_b32 s21, s63, 3
    s_lshl_b32 s21, s21, 8
    s_add_u32 s23, s23, s21
    s_add_u32 s23, s23, 1187840
    s_add_u32 s22, s23, 4096
    v_lshrrev_b32 v6, 4, v1
    v_lshlrev_b32 v6, 10, v6
    v_lshl_add_u32 v6, v2, 4, v6
    s_mov_b32 s65, 100015
    s_and_b32 s20, s65, 3
    s_cmp_eq_u32 s20, 0
    s_cselect_b32 s20, 1179648, 0
    s_sub_u32 s21, s23, s20
    s_sub_u32 s20, s22, s20
    buffer_load_dwordx4 v[96:99], v6, s[32:35], s21 offen sc1
    buffer_load_dwordx4 v[100:103], v6, s[32:35], s21 offen offset:512 sc1
    buffer_load_dwordx4 v[104:107], v6, s[32:35], s20 offen sc1
    buffer_load_dwordx4 v[108:111], v6, s[32:35], s20 offen offset:512 sc1
    s_waitcnt vmcnt(0)
    v_xor_b32 v8, s18, v97
    v_bitop3_b32 v8, v99, s19, v8 bitop3:0xbe
    v_bitop3_b32 v8, v101, s18, v8 bitop3:0xbe
    v_bitop3_b32 v8, v103, s19, v8 bitop3:0xbe
    v_bitop3_b32 v8, v105, s18, v8 bitop3:0xbe
    v_bitop3_b32 v8, v107, s19, v8 bitop3:0xbe
    v_bitop3_b32 v8, v109, s18, v8 bitop3:0xbe
    v_bitop3_b32 v8, v111, s19, v8 bitop3:0xbe
    v_cmp_ne_u32 vcc, 0, v8
    s_nop 4
    s_cbranch_vccz L_qearly
    s_sub_u32 s65, s65, 1
    s_and_b32 s20, s65, 3
    s_cmp_eq_u32 s20, 0
    s_cselect_b32 s20, 1179648, 0
    s_sub_u32 s21, s23, s20
    s_sub_u32 s20, s22, s20
    buffer_load_dwordx4 v[96:99], v6, s[32:35], s21 offen sc1
    buffer_load_dwordx4 v[100:103], v6, s[32:35], s21 offen offset:512 sc1
    buffer_load_dwordx4 v[104:107], v6, s[32:35], s20 offen sc1
    buffer_load_dwordx4 v[108:111], v6, s[32:35], s20 offen offset:512 sc1
    s_waitcnt vmcnt(0)
    v_xor_b32 v8, s18, v97
    v_bitop3_b32 v8, v99, s19, v8 bitop3:0xbe
    v_bitop3_b32 v8, v101, s18, v8 bitop3:0xbe
    v_bitop3_b32 v8, v103, s19, v8 bitop3:0xbe
    v_bitop3_b32 v8, v105, s18, v8 bitop3:0xbe
    v_bitop3_b32 v8, v107, s19, v8 bitop3:0xbe
    v_bitop3_b32 v8, v109, s18, v8 bitop3:0xbe
    v_bitop3_b32 v8, v111, s19, v8 bitop3:0xbe
    v_cmp_ne_u32 vcc, 0, v8
    s_nop 4
    s_cbranch_vccz L_qearly
    s_mov_b32 exec_lo, 0x55555555
    s_mov_b32 exec_hi, 0x55555555
    buffer_store_dwordx4 v[116:119], v120, s[32:35], s4 offen sc1
    s_mov_b64 exec, -1
    s_sub_u32 s65, s65, 1
L_qd:
    s_and_b32 s20, s65, 3
    s_cmp_eq_u32 s20, 0
    s_cselect_b32 s20, 1179648, 0
    s_sub_u32 s21, s23, s20
    s_sub_u32 s20, s22, s20
    buffer_load_dwordx4 v[96:99], v6, s[32:35], s21 offen sc1
    buffer_load_dwordx4 v[100:103], v6, s[32:35], s21 offen offset:512 sc1
    buffer_load_dwordx4 v[104:107], v6, s[32:35], s20 offen sc1
    buffer_load_dwordx4 v[108:111], v6, s[32:35], s20 offen offset:512 sc1
    s_waitcnt vmcnt(0)
    v_xor_b32 v8, s18, v97
    v_bitop3_b32 v8, v99, s19, v8 bitop3:0xbe
    v_bitop3_b32 v8, v101, s18, v8 bitop3:0xbe
    v_bitop3_b32 v8, v103, s19, v8 bitop3:0xbe
    v_bitop3_b32 v8, v105, s18, v8 bitop3:0xbe
    v_bitop3_b32 v8, v107, s19, v8 bitop3:0xbe
    v_bitop3_b32 v8, v109, s18, v8 bitop3:0xbe
    v_bitop3_b32 v8, v111, s19, v8 bitop3:0xbe
    v_cmp_ne_u32 vcc, 0, v8
    s_nop 4
    s_cbranch_vccz L_qdok
    s_sub_u32 s65, s65, 1
    s_cmp_lg_u32 s65, 0
    s_cbranch_scc1 L_qd
    s_branch L_end
L_qearly:
    s_mov_b32 exec_lo, 0x55555555
    s_mov_b32 exec_hi, 0x55555555
    buffer_store_dwordx4 v[116:119], v120, s[32:35], s4 offen sc1
    s_mov_b64 exec, -1
L_qdok:
    s_mov_b32 s20, 0xffff0000
    v_lshlrev_b32 v8, 16, v96
    v_lshlrev_b32 v9, 16, v100
    v_and_b32 v10, s20, v96
    v_and_b32 v11, s20, v100
    v_add_f32 v8, v8, v9
    v_add_f32 v10, v10, v11
    v_cvt_pk_bf16_f32 v112, v8, v10
    v_lshlrev_b32 v8, 16, v98
    v_lshlrev_b32 v9, 16, v102
    v_and_b32 v10, s20, v98
    v_and_b32 v11, s20, v102
    v_add_f32 v8, v8, v9
    v_add_f32 v10, v10, v11
    v_cvt_pk_bf16_f32 v113, v8, v10
    v_lshlrev_b32 v8, 16, v104
    v_lshlrev_b32 v9, 16, v108
    v_and_b32 v10, s20, v104
    v_and_b32 v11, s20, v108
    v_add_f32 v8, v8, v9
    v_add_f32 v10, v10, v11
    v_cvt_pk_bf16_f32 v114, v8, v10
    v_lshlrev_b32 v8, 16, v106
    v_lshlrev_b32 v9, 16, v110
    v_and_b32 v10, s20, v106
    v_and_b32 v11, s20, v110
    v_add_f32 v8, v8, v9
    v_add_f32 v10, v10, v11
    v_cvt_pk_bf16_f32 v115, v8, v10
    v_lshlrev_b32 v6, 3, v1
    ds_write_b64 v6, v[112:113] offset:8192
    ds_write_b64 v6, v[114:115] offset:8704
    v_mov_b32 v8, 0
    v_mov_b32 v9, 1
    s_waitcnt lgkmcnt(0)
    ds_write_b32 v8, v9 offset:9504
    s_cmp_lg_u32 s66, 0
    s_cbranch_scc1 L_h_nounit
    s_add_u32 s20, s13, 0
    buffer_load_dwordx4 v[64:67], v5, s[28:31], s20 offen offset:0 nt
    buffer_load_dwordx4 v[68:71], v5, s[28:31], s20 offen offset:1024 nt
    buffer_load_dwordx4 v[72:75], v5, s[28:31], s20 offen offset:2048 nt
    buffer_load_dwordx4 v[76:79], v5, s[28:31], s20 offen offset:3072 nt
    s_add_u32 s20, s13, 4096
    buffer_load_dwordx4 v[80:83], v5, s[28:31], s20 offen offset:0 nt
    buffer_load_dwordx4 v[84:87], v5, s[28:31], s20 offen offset:1024 nt
    buffer_load_dwordx4 v[88:91], v5, s[28:31], s20 offen offset:2048 nt
    buffer_load_dwordx4 v[92:95], v5, s[28:31], s20 offen offset:3072 nt
    s_lshl_b32 s20, s12, 12
    s_add_u32 s20, s20, 28672
    v_lshlrev_b32 v56, 2, v3
    v_lshlrev_b32 v57, 8, v2
    v_add_u32 v57, s20, v57
    v_or_b32 v58, 0, v56
    v_xor_b32 v59, v58, v2
    v_lshlrev_b32 v59, 4, v59
    v_lshl_add_u32 v59, v58, 8, v59
    v_add_u32 v48, s20, v59
    v_or_b32 v58, 1, v56
    v_xor_b32 v59, v58, v2
    v_lshlrev_b32 v59, 4, v59
    v_lshl_add_u32 v59, v58, 8, v59
    v_add_u32 v49, s20, v59
    v_or_b32 v58, 2, v56
    v_xor_b32 v59, v58, v2
    v_lshlrev_b32 v59, 4, v59
    v_lshl_add_u32 v59, v58, 8, v59
    v_add_u32 v50, s20, v59
    v_or_b32 v58, 3, v56
    v_xor_b32 v59, v58, v2
    v_lshlrev_b32 v59, 4, v59
    v_lshl_add_u32 v59, v58, 8, v59
    v_add_u32 v51, s20, v59
    v_or_b32 v58, 0, v3
    v_xor_b32 v58, v58, v2
    v_lshl_add_u32 v52, v58, 4, v57
    v_or_b32 v58, 4, v3
    v_xor_b32 v58, v58, v2
    v_lshl_add_u32 v53, v58, 4, v57
    v_or_b32 v58, 8, v3
    v_xor_b32 v58, v58, v2
    v_lshl_add_u32 v54, v58, 4, v57
    v_or_b32 v58, 12, v3
    v_xor_b32 v58, v58, v2
    v_lshl_add_u32 v55, v58, 4, v57
    s_waitcnt vmcnt(63)
    ds_write_b128 v48, a[0:3]
    ds_write_b128 v49, a[4:7]
    ds_write_b128 v50, a[8:11]
    ds_write_b128 v51, a[12:15]
    ds_read_b128 a[0:3], v52
    ds_read_b128 a[4:7], v53
    ds_read_b128 a[8:11], v54
    ds_read_b128 a[12:15], v55
    s_waitcnt vmcnt(63)
    ds_write_b128 v48, a[16:19]
    ds_write_b128 v49, a[20:23]
    ds_write_b128 v50, a[24:27]
    ds_write_b128 v51, a[28:31]
    s_waitcnt lgkmcnt(8)
    ds_read_b128 a[16:19], v52
    ds_read_b128 a[20:23], v53
    ds_read_b128 a[24:27], v54
    ds_read_b128 a[28:31], v55
    s_waitcnt lgkmcnt(0)
    v_and_b32 v6, 3, v2
    v_lshlrev_b32 v6, 8, v6
    v_lshl_add_u32 v6, v3, 4, v6
    ds_read_b128 v[32:35], v6 offset:8192
    ds_read_b128 v[36:39], v6 offset:8256
    ds_read_b128 v[40:43], v6 offset:8320
    ds_read_b128 v[44:47], v6 offset:8384
    s_waitcnt lgkmcnt(0)
    v_mfma_f32_16x16x32_bf16 v[8:11], a[0:3], v[32:35], 0
    v_mfma_f32_16x16x32_bf16 v[8:11], a[4:7], v[36:39], v[8:11]
    v_mfma_f32_16x16x32_bf16 v[8:11], a[8:11], v[40:43], v[8:11]
    v_mfma_f32_16x16x32_bf16 v[8:11], a[12:15], v[44:47], v[8:11]
    v_mfma_f32_16x16x32_bf16 v[12:15], a[16:19], v[32:35], 0
    v_mfma_f32_16x16x32_bf16 v[12:15], a[20:23], v[36:39], v[12:15]
    v_mfma_f32_16x16x32_bf16 v[12:15], a[24:27], v[40:43], v[12:15]
    v_mfma_f32_16x16x32_bf16 v[12:15], a[28:31], v[44:47], v[12:15]
    s_nop 7
    s_lshl_b32 s20, s12, 4
    v_lshlrev_b32 v7, 2, v1
    v_add_u32 v7, s20, v7
    v_max3_f32 v44, v8, v9, v10
    v_max3_f32 v44, v44, v11, v12
    v_max3_f32 v44, v44, v13, v14
    v_max_f32 v44, v44, v15
    v_mov_b32 v32, v44
    s_nop 1
    v_permlane32_swap_b32 v44, v32
    v_max_f32 v44, v44, v32
    v_mov_b32 v32, v44
    s_nop 1
    v_permlane16_swap_b32 v44, v32
    v_max_f32 v44, v44, v32
    v_mul_f32 v32, s42, v44
    v_fma_f32 v8, v8, s42, -v32
    v_fma_f32 v9, v9, s42, -v32
    v_fma_f32 v10, v10, s42, -v32
    v_fma_f32 v11, v11, s42, -v32
    v_fma_f32 v12, v12, s42, -v32
    v_fma_f32 v13, v13, s42, -v32
    v_fma_f32 v14, v14, s42, -v32
    v_fma_f32 v15, v15, s42, -v32
    v_exp_f32 v8, v8
    v_exp_f32 v9, v9
    v_exp_f32 v10, v10
    v_exp_f32 v11, v11
    v_exp_f32 v12, v12
    v_exp_f32 v13, v13
    v_exp_f32 v14, v14
    v_exp_f32 v15, v15
    v_pk_add_f32 v[34:35], v[8:9], v[10:11]
    v_pk_add_f32 v[36:37], v[12:13], v[14:15]
    v_pk_add_f32 v[34:35], v[34:35], v[36:37]
    v_cvt_pk_bf16_f32 v8, v8, v9
    v_cvt_pk_bf16_f32 v9, v10, v11
    v_cvt_pk_bf16_f32 v10, v12, v13
    v_cvt_pk_bf16_f32 v11, v14, v15
    v_add_f32 v45, v34, v35
    v_mov_b32 v33, v45
    s_nop 1
    v_permlane32_swap_b32 v45, v33
    v_add_f32 v45, v45, v33
    v_mov_b32 v33, v45
    s_nop 1
    v_permlane16_swap_b32 v45, v33
    v_add_f32 v45, v45, v33
    s_mov_b64 exec, 0xf
    ds_write_b32 v7, v44 offset:9216
    ds_write_b32 v7, v45 offset:9344
    s_mov_b64 exec, -1
    s_lshl_b32 s20, s12, 2
    v_mov_b32 v6, s20
    v_mov_b32 v7, 1
    s_waitcnt lgkmcnt(0)
    ds_write_b32 v6, v7 offset:9536
    v_lshlrev_b32 v6, 4, v0
    v_add_u32 v6, 61952, v6
    ds_read_b128 v[20:23], v6
    ds_read_b128 v[24:27], v6 offset:8192
    ds_read_b64 v[28:29], v6 offset:16384
    s_waitcnt vmcnt(0)
    v_perm_b32 v32, v68, v64, s40
    v_perm_b32 v33, v76, v72, s40
    v_perm_b32 v34, v84, v80, s40
    v_perm_b32 v35, v92, v88, s40
    v_perm_b32 v36, v68, v64, s41
    v_perm_b32 v37, v76, v72, s41
    v_perm_b32 v38, v84, v80, s41
    v_perm_b32 v39, v92, v88, s41
    v_mfma_f32_16x16x32_bf16 a[0:3], v[8:11], v[32:35], 0
    v_perm_b32 v40, v69, v65, s40
    v_perm_b32 v41, v77, v73, s40
    v_perm_b32 v42, v85, v81, s40
    v_perm_b32 v43, v93, v89, s40
    v_mfma_f32_16x16x32_bf16 a[4:7], v[8:11], v[36:39], 0
    v_perm_b32 v44, v69, v65, s41
    v_perm_b32 v45, v77, v73, s41
    v_perm_b32 v46, v85, v81, s41
    v_perm_b32 v47, v93, v89, s41
    v_mfma_f32_16x16x32_bf16 a[8:11], v[8:11], v[40:43], 0
    v_perm_b32 v32, v70, v66, s40
    v_perm_b32 v33, v78, v74, s40
    v_perm_b32 v34, v86, v82, s40
    v_perm_b32 v35, v94, v90, s40
    v_mfma_f32_16x16x32_bf16 a[12:15], v[8:11], v[44:47], 0
    v_perm_b32 v36, v70, v66, s41
    v_perm_b32 v37, v78, v74, s41
    v_perm_b32 v38, v86, v82, s41
    v_perm_b32 v39, v94, v90, s41
    v_mfma_f32_16x16x32_bf16 a[16:19], v[8:11], v[32:35], 0
    v_perm_b32 v40, v71, v67, s40
    v_perm_b32 v41, v79, v75, s40
    v_perm_b32 v42, v87, v83, s40
    v_perm_b32 v43, v95, v91, s40
    v_mfma_f32_16x16x32_bf16 a[20:23], v[8:11], v[36:39], 0
    v_perm_b32 v44, v71, v67, s41
    v_perm_b32 v45, v79, v75, s41
    v_perm_b32 v46, v87, v83, s41
    v_perm_b32 v47, v95, v91, s41
    v_mfma_f32_16x16x32_bf16 a[24:27], v[8:11], v[40:43], 0
    s_nop 1
    v_mfma_f32_16x16x32_bf16 a[28:31], v[8:11], v[44:47], 0
    v_lshlrev_b32 v6, 12, v3
    v_lshl_add_u32 v6, v2, 4, v6
    buffer_load_dwordx4 v[48:51], v6, s[48:51], s7 offen offset:0 nt
    buffer_load_dwordx4 v[52:55], v6, s[48:51], s7 offen offset:1024 nt
    buffer_load_dwordx4 v[56:59], v6, s[48:51], s7 offen offset:2048 nt
    buffer_load_dwordx4 v[60:63], v6, s[48:51], s7 offen offset:3072 nt
    s_nop 4
    s_waitcnt lgkmcnt(0)
    s_mov_b64 exec, 0xffff
    ds_write_b128 v28, a[0:3] offset:10240
    ds_write_b128 v28, a[4:7] offset:10256
    ds_write_b128 v28, a[8:11] offset:10272
    ds_write_b128 v28, a[12:15] offset:10288
    ds_write_b128 v28, a[16:19] offset:10304
    ds_write_b128 v28, a[20:23] offset:10320
    ds_write_b128 v28, a[24:27] offset:10336
    s_nop 1
    ds_write_b128 v28, a[28:31] offset:10352
    s_mov_b64 exec, -1
    s_waitcnt lgkmcnt(0)
    s_branch L_h_norm
L_h_nounit:
    s_lshl_b32 s20, s12, 4
    v_lshlrev_b32 v7, 2, v1
    v_add_u32 v7, s20, v7
    v_mov_b32 v44, 0xff800000
    v_mov_b32 v45, 0
    s_mov_b64 exec, 0xf
    ds_write_b32 v7, v44 offset:9216
    ds_write_b32 v7, v45 offset:9344
    s_mov_b64 exec, -1
    s_lshl_b32 s20, s12, 2
    v_mov_b32 v6, s20
    v_mov_b32 v7, 1
    s_waitcnt lgkmcnt(0)
    ds_write_b32 v6, v7 offset:9536
    v_lshlrev_b32 v6, 4, v0
    v_add_u32 v6, 61952, v6
    ds_read_b128 v[20:23], v6
    ds_read_b128 v[24:27], v6 offset:8192
    ds_read_b64 v[28:29], v6 offset:16384
    v_lshlrev_b32 v6, 12, v3
    v_lshl_add_u32 v6, v2, 4, v6
    buffer_load_dwordx4 v[48:51], v6, s[48:51], s7 offen offset:0 nt
    buffer_load_dwordx4 v[52:55], v6, s[48:51], s7 offen offset:1024 nt
    buffer_load_dwordx4 v[56:59], v6, s[48:51], s7 offen offset:2048 nt
    buffer_load_dwordx4 v[60:63], v6, s[48:51], s7 offen offset:3072 nt
    v_mov_b32 v32, 0
    v_mov_b32 v33, 0
    v_mov_b32 v34, 0
    v_mov_b32 v35, 0
    s_waitcnt lgkmcnt(0)
    s_mov_b64 exec, 0xffff
    ds_write_b128 v28, v[32:35] offset:10240
    ds_write_b128 v28, v[32:35] offset:10256
    ds_write_b128 v28, v[32:35] offset:10272
    ds_write_b128 v28, v[32:35] offset:10288
    ds_write_b128 v28, v[32:35] offset:10304
    ds_write_b128 v28, v[32:35] offset:10320
    ds_write_b128 v28, v[32:35] offset:10336
    ds_write_b128 v28, v[32:35] offset:10352
    s_mov_b64 exec, -1
    s_waitcnt lgkmcnt(0)
L_h_norm:
    s_mov_b32 s65, 5000750
    v_and_b32 v6, 7, v1
    v_lshlrev_b32 v6, 2, v6
L_sw:
    ds_read_b32 v8, v6 offset:9536
    s_waitcnt lgkmcnt(0)
    v_cmp_ne_u32 vcc, 1, v8
    s_nop 4
    s_cbranch_vccz L_swok
    s_sub_u32 s65, s65, 1
    s_cmp_lg_u32 s65, 0
    s_cbranch_scc1 L_sw
    s_branch L_end
L_swok:
    v_and_b32 v8, 7, v1
    v_bfe_u32 v9, v1, 3, 2
    v_lshlrev_b32 v10, 4, v8
    v_lshl_add_u32 v10, v9, 2, v10
    ds_read_b32 v11, v10 offset:9216
    ds_read_b32 v12, v10 offset:9344
    v_lshlrev_b32 v10, 5, v9
    v_lshl_add_u32 v10, v8, 2, v10
    v_lshlrev_b32 v9, 2, v9
    s_waitcnt lgkmcnt(0)
    v_mov_b32 v13, v11
    s_nop 1
    v_max_f32_dpp v13, v13, v13 quad_perm:[1,0,3,2] row_mask:0xf bank_mask:0xf
    s_nop 1
    v_max_f32_dpp v13, v13, v13 quad_perm:[2,3,0,1] row_mask:0xf bank_mask:0xf
    s_nop 1
    v_max_f32_dpp v13, v13, v13 row_half_mirror row_mask:0xf bank_mask:0xf
    s_nop 1
    v_sub_f32 v11, v11, v13
    v_mul_f32 v11, s42, v11
    v_exp_f32 v11, v11
    s_nop 0
    v_mul_f32 v12, v11, v12
    s_nop 1
    v_add_f32_dpp v12, v12, v12 quad_perm:[1,0,3,2] row_mask:0xf bank_mask:0xf
    s_nop 1
    v_add_f32_dpp v12, v12, v12 quad_perm:[2,3,0,1] row_mask:0xf bank_mask:0xf
    s_nop 1
    v_add_f32_dpp v12, v12, v12 row_half_mirror row_mask:0xf bank_mask:0xf
    s_nop 1
    v_log_f32 v14, v12
    v_rcp_f32 v12, v12
    s_and_b32 s20, s19, 0xff
    v_fma_f32 v13, v13, s42, v14
    v_mul_f32 v11, v11, v12
    v_and_b32 v13, 0xffffff00, v13
    v_or_b32 v13, s20, v13
    ds_write_b32 v10, v11 offset:9600
    ds_write_b32 v9, v13 offset:9728
    s_waitcnt lgkmcnt(0)
L_D:
    s_barrier
    v_and_b32 v7, 3, v1
    v_lshlrev_b32 v6, 5, v7
    v_lshlrev_b32 v7, 2, v7
    ds_read_b32 v8, v20 offset:10240
    ds_read_b32 v9, v20 offset:12544
    ds_read_b32 v10, v20 offset:14848
    ds_read_b32 v11, v20 offset:17152
    ds_read_b32 v12, v20 offset:19456
    ds_read_b32 v13, v20 offset:21760
    ds_read_b32 v14, v20 offset:24064
    ds_read_b32 v15, v20 offset:26368
    ds_read_b128 v[32:35], v6 offset:9600
    ds_read_b128 v[36:39], v6 offset:9616
    ds_read_b32 v18, v7 offset:9728
    v_mov_b32 v19, s18
    s_add_u32 s22, s67, 1179648
    s_mov_b32 s20, 0x000f000f
    s_mov_b32 s21, 0x000f000f
    s_waitcnt lgkmcnt(1)
    v_mul_f32 v8, v32, v8
    v_mul_f32 v9, v33, v9
    v_fma_f32 v8, v10, v34, v8
    v_fma_f32 v9, v11, v35, v9
    v_fma_f32 v8, v12, v36, v8
    v_fma_f32 v9, v13, v37, v9
    v_fma_f32 v8, v14, v38, v8
    v_fma_f32 v9, v15, v39, v9
    v_add_f32 v8, v8, v9
    s_nop 1
    v_mov_b32_dpp v9, v8 row_shl:4 row_mask:0xf bank_mask:0xf
    v_cvt_pk_bf16_f32 v16, v8, v9
    s_waitcnt lgkmcnt(0)
    s_nop 0
    v_mov_b32_dpp v17, v16 row_shl:8 row_mask:0xf bank_mask:0xf
    s_mov_b64 exec, s[20:21]
    buffer_store_dwordx4 v[16:19], v21, s[32:35], s22 offen
    buffer_store_dwordx4 v[16:19], v21, s[32:35], s67 offen sc1
    s_mov_b64 exec, -1
    s_waitcnt vmcnt(2)
    s_branch L_join
L_spare_h:
    s_mov_b32 exec_lo, 0x55555555
    s_mov_b32 exec_hi, 0x55555555
    buffer_store_dwordx4 v[116:119], v120, s[32:35], s4 offen sc1
    s_mov_b64 exec, -1
L_spare_rest:
    v_lshlrev_b32 v6, 12, v3
    v_lshl_add_u32 v6, v2, 4, v6
    buffer_load_dwordx4 v[48:51], v6, s[48:51], s7 offen offset:0 nt
    buffer_load_dwordx4 v[52:55], v6, s[48:51], s7 offen offset:1024 nt
    buffer_load_dwordx4 v[56:59], v6, s[48:51], s7 offen offset:2048 nt
    buffer_load_dwordx4 v[60:63], v6, s[48:51], s7 offen offset:3072 nt
    v_lshlrev_b32 v6, 4, v0
    v_add_u32 v6, 61952, v6
    ds_read_b128 v[20:23], v6
    ds_read_b128 v[24:27], v6 offset:8192
    ds_read_b64 v[28:29], v6 offset:16384
    s_lshr_b32 s21, s8, 1
    s_lshl_b32 s22, s60, 2
    s_add_u32 s21, s21, s22
    s_and_b32 s22, s8, 1
    s_lshl_b32 s23, s21, 16
    s_lshl_b32 s4, s22, 10
    s_add_u32 s23, s23, s4
    s_lshl_b32 s4, s12, 7
    s_add_u32 s23, s23, s4
    s_add_u32 s69, s23, 630784
    s_add_u32 s3, s69, 16384
    s_add_u32 s4, s69, 32768
    s_add_u32 s5, s69, 49152
    v_lshrrev_b32 v122, 3, v1
    v_lshlrev_b32 v122, 11, v122
    v_and_b32 v123, 7, v1
    v_lshl_add_u32 v122, v123, 4, v122
    s_lshl_b32 s22, s22, 11
    s_lshl_b32 s21, s21, 8
    s_add_u32 s22, s22, s21
    s_lshl_b32 s21, s12, 5
    s_add_u32 s10, s22, s21
    v_lshlrev_b32 v123, 2, v1
    s_waitcnt lgkmcnt(0)
    s_cmp_lg_u32 s12, 0
    s_cbranch_scc1 L_quiet_done
    s_mov_b32 s65, 100015
L_quiet:
    s_and_b32 s66, s65, 15
    s_cmp_eq_u32 s66, 0
    s_cselect_b32 s66, 1179648, 0
    s_sub_u32 s66, s44, s66
    s_mov_b64 exec, s[46:47]
    buffer_load_dwordx4 v[96:99], v24, s[32:35], s66 offen sc1
    s_mov_b64 exec, -1
    s_waitcnt vmcnt(0)
    v_cmp_eq_u32 vcc, s16, v99
    s_nop 4
    s_and_b64 vcc, vcc, s[46:47]
    s_cbranch_scc1 L_quiet_done
    s_sub_u32 s65, s65, 1
    s_cmp_lg_u32 s65, 0
    s_cbranch_scc1 L_quiet
    s_branch L_end
L_quiet_done:
    s_barrier
    s_waitcnt vmcnt(0)
L_join:
    v_perm_b32 v32, v52, v48, s40
    v_perm_b32 v33, v60, v56, s40
    ds_write_b64 v27, v[32:33] offset:28672
    v_perm_b32 v34, v52, v48, s41
    v_perm_b32 v35, v60, v56, s41
    ds_write_b64 v27, v[34:35] offset:28688
    v_perm_b32 v36, v53, v49, s40
    v_perm_b32 v37, v61, v57, s40
    ds_write_b64 v27, v[36:37] offset:28704
    v_perm_b32 v38, v53, v49, s41
    v_perm_b32 v39, v61, v57, s41
    ds_write_b64 v27, v[38:39] offset:28720
    v_perm_b32 v40, v54, v50, s40
    v_perm_b32 v41, v62, v58, s40
    ds_write_b64 v27, v[40:41] offset:28736
    v_perm_b32 v42, v54, v50, s41
    v_perm_b32 v43, v62, v58, s41
    ds_write_b64 v27, v[42:43] offset:28752
    v_perm_b32 v44, v55, v51, s40
    v_perm_b32 v45, v63, v59, s40
    ds_write_b64 v27, v[44:45] offset:28768
    v_perm_b32 v46, v55, v51, s41
    v_perm_b32 v47, v63, v59, s41
    ds_write_b64 v27, v[46:47] offset:28784
    buffer_load_dwordx4 v[96:99], v24, s[32:35], s44 offen sc1
    buffer_load_dwordx4 v[100:103], v25, s[32:35], s44 offen sc1
    s_waitcnt lgkmcnt(0)
    s_barrier
    ds_read_b128 v[64:67], v22 offset:28672
    ds_read_b128 v[68:71], v22 offset:29696
    ds_read_b128 v[72:75], v22 offset:30720
    ds_read_b128 v[76:79], v22 offset:31744
    v_mov_b32 v13, s16
    v_mov_b32 v15, s17
    s_mov_b32 s65, 100015
    s_branch L_t2w
L_t2:
    s_and_b32 s66, s65, 15
    s_cmp_eq_u32 s66, 0
    s_cselect_b32 s66, 1179648, 0
    s_sub_u32 s66, s44, s66
    s_mov_b64 exec, s[62:63]
    s_cbranch_execz L_t2s0
    buffer_load_dwordx4 v[96:99], v24, s[32:35], s66 offen sc1
L_t2s0:
    s_mov_b64 exec, s[20:21]
    s_cbranch_execz L_t2s1
    buffer_load_dwordx4 v[100:103], v25, s[32:35], s66 offen sc1
L_t2s1:
    s_mov_b64 exec, -1
L_t2w:
    s_waitcnt vmcnt(0)
    v_lshlrev_b32 v8, 24, v98
    v_lshlrev_b32 v9, 24, v102
    v_xor_b32 v8, s45, v8
    v_xor_b32 v9, s45, v9
    v_bitop3_b32 v8, v99, s16, v8 bitop3:0xbe
    v_bitop3_b32 v9, v103, s16, v9 bitop3:0xbe
    v_cmp_ne_u32 vcc, 0, v8
    v_cmp_ne_u32 s[20:21], 0, v9
    v_mov_b32 v10, 0xff800000
    s_nop 2
    s_and_b64 s[62:63], vcc, s[46:47]
    s_and_b64 s[20:21], s[20:21], s[14:15]
    s_or_b64 vcc, s[62:63], s[20:21]
    s_cbranch_scc0 L_t2ok
    s_sub_u32 s65, s65, 1
    s_cmp_lg_u32 s65, 0
    s_cbranch_scc1 L_t2
    s_branch L_end
L_t2ok:
    s_mov_b32 s20, 0xffff0000
    v_and_b32 v98, 0xffffff00, v98
    v_and_b32 v102, 0xffffff00, v102
    v_cndmask_b32 v98, v10, v98, s[46:47]
    v_cndmask_b32 v102, v10, v102, s[14:15]
    v_max_f32 v8, v98, v102
    v_lshlrev_b32 v104, 16, v96
    v_and_b32 v105, s20, v96
    v_max_f32_dpp v8, v8, v8 quad_perm:[1,0,3,2] row_mask:0xf bank_mask:0xf
    v_lshlrev_b32 v106, 16, v97
    v_and_b32 v107, s20, v97
    v_max_f32_dpp v8, v8, v8 quad_perm:[2,3,0,1] row_mask:0xf bank_mask:0xf
    v_lshlrev_b32 v108, 16, v100
    v_and_b32 v109, s20, v100
    v_max_f32_dpp v8, v8, v8 row_ror:8 row_mask:0xf bank_mask:0xf
    v_lshlrev_b32 v110, 16, v101
    v_and_b32 v111, s20, v101
    v_sub_f32 v98, v98, v8
    v_sub_f32 v102, v102, v8
    v_exp_f32 v98, v98
    v_exp_f32 v102, v102
    s_nop 0
    v_add_f32 v114, v98, v102
    v_mul_f32 v104, v98, v104
    v_mul_f32 v105, v98, v105
    v_mul_f32 v106, v98, v106
    v_mul_f32 v107, v98, v107
    v_fma_f32 v104, v102, v108, v104
    v_fma_f32 v105, v102, v109, v105
    v_fma_f32 v106, v102, v110, v106
    v_fma_f32 v107, v102, v111, v107
    v_add_f32_dpp v114, v114, v114 quad_perm:[1,0,3,2] row_mask:0xf bank_mask:0xf
    v_add_f32_dpp v104, v104, v104 quad_perm:[1,0,3,2] row_mask:0xf bank_mask:0xf
    v_add_f32_dpp v105, v105, v105 quad_perm:[1,0,3,2] row_mask:0xf bank_mask:0xf
    v_add_f32_dpp v106, v106, v106 quad_perm:[1,0,3,2] row_mask:0xf bank_mask:0xf
    v_add_f32_dpp v107, v107, v107 quad_perm:[1,0,3,2] row_mask:0xf bank_mask:0xf
    v_add_f32_dpp v114, v114, v114 quad_perm:[2,3,0,1] row_mask:0xf bank_mask:0xf
    v_add_f32_dpp v104, v104, v104 quad_perm:[2,3,0,1] row_mask:0xf bank_mask:0xf
    v_add_f32_dpp v105, v105, v105 quad_perm:[2,3,0,1] row_mask:0xf bank_mask:0xf
    v_add_f32_dpp v106, v106, v106 quad_perm:[2,3,0,1] row_mask:0xf bank_mask:0xf
    v_add_f32_dpp v107, v107, v107 quad_perm:[2,3,0,1] row_mask:0xf bank_mask:0xf
    v_add_f32_dpp v114, v114, v114 row_ror:8 row_mask:0xf bank_mask:0xf
    v_add_f32_dpp v104, v104, v104 row_ror:8 row_mask:0xf bank_mask:0xf
    v_add_f32_dpp v105, v105, v105 row_ror:8 row_mask:0xf bank_mask:0xf
    v_add_f32_dpp v106, v106, v106 row_ror:8 row_mask:0xf bank_mask:0xf
    v_add_f32_dpp v107, v107, v107 row_ror:8 row_mask:0xf bank_mask:0xf
    v_rcp_f32 v114, v114
    s_mov_b32 s20, 0x00110011
    v_mul_f32 v104, v114, v104
    v_mul_f32 v105, v114, v105
    v_mul_f32 v106, v114, v106
    v_mul_f32 v107, v114, v107
    v_cvt_pk_bf16_f32 v96, v104, v105
    v_cvt_pk_bf16_f32 v97, v106, v107
    s_mov_b32 exec_lo, s20
    s_mov_b32 exec_hi, s20
    ds_write_b64 v23, v[96:97] offset:9728
    s_mov_b64 exec, -1
    s_waitcnt lgkmcnt(0)
    s_barrier
    ds_read_b128 v[80:83], v26 offset:9728
    ds_read_b128 v[84:87], v26 offset:9792
    ds_read_b128 v[88:91], v26 offset:9856
    ds_read_b128 v[92:95], v26 offset:9920
    s_waitcnt lgkmcnt(3)
    v_mfma_f32_16x16x32_bf16 v[8:11], v[80:83], v[64:67], 0
    s_waitcnt lgkmcnt(2)
    v_mfma_f32_16x16x32_bf16 v[8:11], v[84:87], v[68:71], v[8:11]
    s_waitcnt lgkmcnt(1)
    v_mfma_f32_16x16x32_bf16 v[8:11], v[88:91], v[72:75], v[8:11]
    s_waitcnt lgkmcnt(0)
    v_mfma_f32_16x16x32_bf16 v[8:11], v[92:95], v[76:79], v[8:11]
    s_mov_b32 s20, 0x55555555
    s_mov_b32 s21, 0
    s_nop 5
    v_mov_b32 v12, v8
    v_mov_b32_dpp v14, v8 quad_perm:[1,0,3,2] row_mask:0xf bank_mask:0xf
    s_mov_b64 exec, s[20:21]
    buffer_store_dwordx4 v[12:15], v29, s[32:35], s6 offen sc1
    s_mov_b64 exec, -1
    s_cmp_eq_u32 s9, 0
    s_cbranch_scc1 L_fin
    s_mov_b32 s65, 100015
    buffer_load_dwordx4 v[32:35], v122, s[32:35], s69 offen sc1
    buffer_load_dwordx4 v[36:39], v122, s[32:35], s3 offen sc1
    buffer_load_dwordx4 v[40:43], v122, s[32:35], s4 offen sc1
    buffer_load_dwordx4 v[44:47], v122, s[32:35], s5 offen sc1
    s_branch L_t4w
L_t4:
    s_mov_b64 exec, s[46:47]
    s_cbranch_execz L_t4s0
    buffer_load_dwordx4 v[32:35], v122, s[32:35], s69 offen sc1
L_t4s0:
    s_mov_b64 exec, s[14:15]
    s_cbranch_execz L_t4s1
    buffer_load_dwordx4 v[36:39], v122, s[32:35], s3 offen sc1
L_t4s1:
    s_mov_b64 exec, s[62:63]
    s_cbranch_execz L_t4s2
    buffer_load_dwordx4 v[40:43], v122, s[32:35], s4 offen sc1
L_t4s2:
    s_mov_b64 exec, s[22:23]
    s_cbranch_execz L_t4s3
    buffer_load_dwordx4 v[44:47], v122, s[32:35], s5 offen sc1
L_t4s3:
    s_mov_b64 exec, -1
L_t4w:
    s_waitcnt vmcnt(0)
    v_xor_b32 v8, s16, v33
    v_xor_b32 v9, s16, v37
    v_xor_b32 v10, s16, v41
    v_xor_b32 v11, s16, v45
    v_bitop3_b32 v8, v35, s17, v8 bitop3:0xbe
    v_bitop3_b32 v9, v39, s17, v9 bitop3:0xbe
    v_bitop3_b32 v10, v43, s17, v10 bitop3:0xbe
    v_bitop3_b32 v11, v47, s17, v11 bitop3:0xbe
    v_cmp_ne_u32 s[46:47], 0, v8
    v_cmp_ne_u32 s[14:15], 0, v9
    v_cmp_ne_u32 s[62:63], 0, v10
    v_cmp_ne_u32 s[22:23], 0, v11
    v_add_f32 v8, v32, v36
    v_add_f32 v9, v34, v38
    v_add_f32 v10, v40, v44
    v_add_f32 v11, v42, v46
    s_or_b64 s[20:21], s[46:47], s[14:15]
    s_or_b64 vcc, s[62:63], s[22:23]
    s_or_b64 vcc, vcc, s[20:21]
    s_cbranch_scc0 L_t4sum
    s_sub_u32 s65, s65, 1
    s_cmp_lg_u32 s65, 0
    s_cbranch_scc1 L_t4
    s_branch L_end
L_t4sum:
    v_add_f32 v8, v8, v10
    v_add_f32 v9, v9, v11
    s_nop 1
    v_add_f32_dpp v8, v8, v8 row_ror:8 row_mask:0xf bank_mask:0xf
    v_add_f32_dpp v9, v9, v9 row_ror:8 row_mask:0xf bank_mask:0xf
    v_mov_b32 v10, v8
    v_mov_b32 v11, v9
    s_nop 1
    v_permlane16_swap_b32 v8, v10
    v_permlane16_swap_b32 v9, v11
    v_add_f32 v8, v8, v10
    v_add_f32 v9, v9, v11
    v_mov_b32 v10, v8
    v_mov_b32 v11, v9
    s_nop 1
    v_permlane32_swap_b32 v8, v10
    v_permlane32_swap_b32 v9, v11
    v_add_f32 v8, v8, v10
    v_add_f32 v9, v9, v11
    v_cvt_pk_bf16_f32 v8, v8, v9
    s_mov_b64 exec, 0xff
    buffer_store_dword v8, v123, s[56:59], s10 offen
    s_mov_b64 exec, -1
    s_or_b32 s20, s8, s12
    s_cmp_lg_u32 s20, 0
    s_cbranch_scc1 L_fin
    v_mov_b32 v8, s16
    v_mov_b32 v9, 0
    s_lshl_b32 s20, s60, 7
    s_mov_b64 exec, 1
    buffer_store_dword v8, v9, s[32:35], s20 offen
    s_mov_b64 exec, -1
L_fin:
L_end:
    s_endpgm
.section .rodata,"a"
.p2align 6
.amdhsa_kernel concat_heads__sliding_block_cached__gqa_block_cached__decode_kernel
  .amdhsa_next_free_vgpr 256
  .amdhsa_next_free_sgpr 102
  .amdhsa_accum_offset 160
  .amdhsa_group_segment_fixed_size 0
  .amdhsa_kernarg_size 104
  .amdhsa_user_sgpr_count 2
  .amdhsa_user_sgpr_kernarg_segment_ptr 1
  .amdhsa_system_sgpr_workgroup_id_x 1
.end_amdhsa_kernel
```
